```python
import torch

def _softmax(x, axis=-1):
    return torch.softmax(x, dim=axis)
def _gelu(x):
    return torch.nn.functional.gelu(x, approximate="tanh")
def _silu(x):
    return torch.nn.functional.silu(x)
def _sigmoid(x):
    return torch.sigmoid(x)
def _layernorm(x, axis=-1, eps=1e-5):
    m = x.mean(dim=axis, keepdim=True)
    v = x.var(dim=axis, keepdim=True, unbiased=False)
    return (x - m) / torch.sqrt(v + eps)
def _scatter_add(tgt, idx, src, axis=0):
    return tgt.clone().index_add_(axis, idx, src)
def _segment_sum(src, seg, n):
    out = torch.zeros((n,) + src.shape[1:], dtype=src.dtype)
    return out.index_add_(0, seg, src)
def _pad(x, pw):
    flat = tuple(v for pair in reversed(pw) for v in pair)
    return torch.nn.functional.pad(x, flat)

kernel_name = 'interleave_layers__ssm_conv_h3__dense_activation_relu__prompt'

def setup_inputs():

    _w = (lambda a: (lambda t: t.to(torch.bfloat16) if t.is_floating_point() else t)(torch.as_tensor(a)))
    def _A_setup():
        B, S, D = 1, 2048, 512
        ks = 4
        return {
            "q": _w((lambda *s: torch.randn(*s, dtype=torch.bfloat16) * 0.05)(B, S, D)),
            "k": _w((lambda *s: torch.randn(*s, dtype=torch.bfloat16) * 0.8)(B, S, D)),
            "v": _w((lambda *s: torch.randn(*s, dtype=torch.bfloat16) * 0.8)(B, S, D)),
            "shift_k": _w((lambda *s: torch.randn(*s, dtype=torch.bfloat16) * 0.8)(D, ks) * 0.5),
            "ssm_k": _w((lambda *s: torch.randn(*s, dtype=torch.bfloat16) * 0.8)(D, S) * (1.0 / S ** 0.5)),
            "ssm_D": _w((lambda *s: torch.randn(*s, dtype=torch.bfloat16) * 0.8)(D)),
        }
    _A_in = _A_setup()

    def _B_setup():
        B, S, D, Dff = 1, 2048, 512, 1376
        return {
            "x": _w((lambda *s: torch.randn(*s, dtype=torch.bfloat16) * 0.05)(B, S, D)),
            "w1": _w((lambda *s: torch.randn(*s, dtype=torch.bfloat16) * 0.1)(D, Dff)),
            "w2": _w((lambda *s: torch.randn(*s, dtype=torch.bfloat16) * 0.1)(Dff, D)),
        }
    _B_in = _B_setup()

    return {
        "A_q": _A_in["q"],
        "A_k": _A_in["k"],
        "A_v": _A_in["v"],
        "A_shift_k": _A_in["shift_k"],
        "A_ssm_k": _A_in["ssm_k"],
        "A_ssm_D": _A_in["ssm_D"],
        "B_x": _B_in["x"],
        "B_w1": _B_in["w1"],
        "B_w2": _B_in["w2"],
    }

def reference(A_q, A_k, A_v, A_shift_k, A_ssm_k, A_ssm_D, B_x, B_w1, B_w2):
    def _A_ref(q, k, v, shift_k, ssm_k, ssm_D):
        B, S, D = q.shape
        ks = shift_k.shape[-1]
        k_pad = _pad(k, ((0, 0), (ks - 1, 0), (0, 0)))
        k_shift = torch.zeros_like(k)
        for t in range(ks):
            k_shift = k_shift + k_pad[:, t:t + S, :] * shift_k[:, ks - 1 - t][None, None, :]
        kv = k_shift * v
        L = 2 * S
        kv_pad = _pad(kv, ((0, 0), (0, S), (0, 0)))
        kf_pad = _pad(ssm_k, ((0, 0), (0, S)))
        kv_f = (lambda x, axes=(-2,-1): torch.fft.rfft2(x.float(), dim=axes))(kv_pad[:, None, :, :], axes=(1, 2))
        kf_f = (lambda x, axes=(-2,-1): torch.fft.rfft2(x.float(), dim=axes))(kf_pad[:, None, :], axes=(1, 2))
        kf_f = (lambda x, *d: x.permute(*d))(kf_f, 1, 2, 0)
        y_f = kv_f * kf_f[None, :, :, :]
        y = (lambda x, s, axes=(-2,-1): torch.fft.irfft2(x, s=s, dim=axes).to(torch.bfloat16))(y_f, (1, L), axes=(1, 2))[:, 0, :S, :]
        y = y + kv * ssm_D[None, None, :]
        return q * y

    def _B_ref(x, w1, w2):
        h = torch.einsum("bsd,df->bsf", x, w1)
        zero = torch.zeros_like(h)
        h = torch.maximum(h, zero)
        return torch.einsum("bsf,fd->bsd", h, w2)

    x = A_q
    x = x + _A_ref(_layernorm(x, axis=-1), A_k, A_v, A_shift_k, A_ssm_k, A_ssm_D)
    x = x + _B_ref(_layernorm(x, axis=-1), B_w1, B_w2)
    x = x + _A_ref(_layernorm(x, axis=-1), A_k, A_v, A_shift_k, A_ssm_k, A_ssm_D)
    x = x + _B_ref(_layernorm(x, axis=-1), B_w1, B_w2)
    return x
```

```asm
; @launch grid=(256,1,1) block=(256,1,1) lds=163840
.amdgcn_target "amdgcn-amd-amdhsa--gfx950"
.text
.globl interleave_layers__ssm_conv_h3__dense_activation_relu__prompt_kernel
.p2align 8
.type interleave_layers__ssm_conv_h3__dense_activation_relu__prompt_kernel,@function
interleave_layers__ssm_conv_h3__dense_activation_relu__prompt_kernel:
    s_cmp_ge_u32 s2, 256
    s_cbranch_scc1 L_end
    s_load_dwordx16 s[16:31], s[0:1], 0
    s_load_dwordx8 s[32:39], s[0:1], 64
    s_memrealtime s[66:67]
    s_getpc_b64 s[68:69]
L_pc:
    s_lshr_b32 s5, s2, 3
    s_lshl_b32 s6, s5, 10
    v_lshl_add_u32 v13, v0, 2, s6
    v_min_u32 v13, L_end-L_pc, v13
    v_mov_b32 v251, s69
    v_add_co_u32 v250, vcc, s68, v13
    s_nop 1
    v_addc_co_u32 v251, vcc, 0, v251, vcc
    global_load_dword v255, v[250:251], off
    s_and_b32 s3, s2, 7
    s_lshl_b32 s8, s3, 5
    s_add_u32 s8, s8, s5
    v_lshrrev_b32 v2, 6, v0
    s_nop 0
    v_readfirstlane_b32 s4, v2
    v_and_b32 v27, 63, v0
    v_lshlrev_b32 v1, 4, v27
    v_and_b32 v2, 15, v0
    v_bfe_u32 v3, v0, 4, 2
    v_mov_b32 v121, 2147418112
    v_mov_b32 v120, 0
    v_mov_b32 v123, v121
    v_mov_b32 v17, v121
    v_mov_b32 v125, v121
    v_mov_b32 v28, v121
    v_mov_b32 v31, v121
    v_lshrrev_b32 v22, 3, v27
    v_and_b32 v21, 7, v27
    s_and_b32 s14, s4, 1
    s_lshl_b32 s10, s3, 2
    s_lshr_b32 s6, s5, 3
    s_add_u32 s10, s10, s6
    s_and_b32 s11, s5, 7
    s_lshl_b32 s12, s10, 10
    s_add_u32 s12, s12, 11665408
    s_lshl_b32 s6, s4, 15
    s_lshl_b32 s7, s8, 7
    s_add_u32 s6, s6, s7
    s_add_u32 s6, s6, 11927552
    v_cmp_eq_u32 vcc, 0, v27
    v_mov_b32 v24, s6
    s_nop 0
    v_cndmask_b32 v24, v121, v24, vcc
    s_mul_i32 s13, s3, 704512
    s_add_u32 s13, s13, 2097152
    s_cmp_ge_u32 s4, 2
    s_cbranch_scc1 L_b1
    v_lshrrev_b32 v13, 5, v0
    v_and_b32 v14, 31, v0
    s_lshl_b32 s6, s5, 16
    s_lshl_b32 s7, s3, 7
    s_add_u32 s6, s6, s7
    v_lshl_add_u32 v4, v13, 14, s6
    v_lshl_add_u32 v4, v14, 2, v4
    v_subrev_u32 v5, 3072, v4
    s_lshl_b32 s7, s3, 9
    v_lshl_add_u32 v6, v14, 4, s7
    s_movk_i32 s61, 4096
    s_movk_i32 s62, 8192
    s_movk_i32 s63, 12288
    s_waitcnt lgkmcnt(0)
    s_mov_b32 s52, s22
    s_mov_b32 s53, s23
    s_mov_b32 s54, 4096
    s_mov_b32 s55, 0x20000
    s_mov_b32 s48, s18
    s_mov_b32 s49, s19
    s_mov_b32 s50, 2097152
    s_mov_b32 s51, 0x20000
    buffer_load_dwordx4 v[64:67], v6, s[52:55], 0 offen
    s_mov_b32 s52, s20
    s_mov_b32 s53, s21
    s_mov_b32 s54, 2097152
    s_mov_b32 s55, 0x20000
    buffer_load_dword v224, v5, s[48:51], 0 offen offset:0
    buffer_load_dword v225, v5, s[48:51], 0 offen offset:1024
    buffer_load_dword v226, v5, s[48:51], 0 offen offset:2048
    buffer_load_dword v227, v4, s[48:51], 0 offen offset:0
    buffer_load_dword v228, v4, s[48:51], 0 offen offset:1024
    buffer_load_dword v229, v4, s[48:51], 0 offen offset:2048
    buffer_load_dword v230, v4, s[48:51], 0 offen offset:3072
    buffer_load_dword v231, v4, s[48:51], s61 offen offset:0
    buffer_load_dword v232, v4, s[48:51], s61 offen offset:1024
    buffer_load_dword v233, v4, s[48:51], s61 offen offset:2048
    buffer_load_dword v234, v4, s[48:51], s61 offen offset:3072
    buffer_load_dword v235, v4, s[48:51], s62 offen offset:0
    buffer_load_dword v236, v4, s[48:51], s62 offen offset:1024
    buffer_load_dword v237, v4, s[48:51], s62 offen offset:2048
    buffer_load_dword v238, v4, s[48:51], s62 offen offset:3072
    buffer_load_dword v239, v4, s[48:51], s63 offen offset:0
    buffer_load_dword v240, v4, s[48:51], s63 offen offset:1024
    buffer_load_dword v241, v4, s[48:51], s63 offen offset:2048
    buffer_load_dword v242, v4, s[48:51], s63 offen offset:3072
    buffer_load_dword v96, v4, s[52:55], 0 offen offset:0
    buffer_load_dword v97, v4, s[52:55], 0 offen offset:1024
    buffer_load_dword v98, v4, s[52:55], 0 offen offset:2048
    buffer_load_dword v99, v4, s[52:55], 0 offen offset:3072
    buffer_load_dword v100, v4, s[52:55], s61 offen offset:0
    buffer_load_dword v101, v4, s[52:55], s61 offen offset:1024
    buffer_load_dword v102, v4, s[52:55], s61 offen offset:2048
    buffer_load_dword v103, v4, s[52:55], s61 offen offset:3072
    buffer_load_dword v104, v4, s[52:55], s62 offen offset:0
    buffer_load_dword v105, v4, s[52:55], s62 offen offset:1024
    buffer_load_dword v106, v4, s[52:55], s62 offen offset:2048
    buffer_load_dword v107, v4, s[52:55], s62 offen offset:3072
    buffer_load_dword v108, v4, s[52:55], s63 offen offset:0
    buffer_load_dword v109, v4, s[52:55], s63 offen offset:1024
    buffer_load_dword v110, v4, s[52:55], s63 offen offset:2048
    buffer_load_dword v111, v4, s[52:55], s63 offen offset:3072
    s_mov_b32 s40, s38
    s_mov_b32 s41, s39
    s_mov_b32 s42, 12582912
    s_mov_b32 s43, 0x20000
    s_xor_b32 s6, s4, 1
    s_or_b32 s6, s6, s11
    s_cmp_eq_u32 s6, 0
    s_cselect_b32 s7, s12, 2147418112
    s_lshl_b32 s6, s8, 10
    s_add_u32 s6, s6, 12058624
    s_cmp_eq_u32 s4, 0
    s_cselect_b32 s7, s6, s7
    v_add_u32 v122, s7, v1
    v_mov_b32 v248, 0
    v_mov_b32 v249, 0
    v_mov_b32 v250, 0
    v_mov_b32 v251, 0
    buffer_store_dwordx4 v[248:251], v122, s[40:43], 0 offen sc1
    s_getreg_b32 s25, hwreg(HW_REG_XCC_ID)
    s_and_b32 s25, s25, 15
    s_mov_b32 s28, 0xffff0000
    s_mul_i32 s6, s4, 4608
    s_add_u32 s6, s6, 98304
    v_mul_u32_u24 v8, 144, v14
    v_and_b32 v13, 1, v13
    v_lshl_add_u32 v8, v13, 5, v8
    v_add_u32 v8, s6, v8
    v_mul_u32_u24 v9, 144, v22
    v_lshl_add_u32 v9, v21, 4, v9
    v_add_u32 v9, s6, v9
    s_lshl_b32 s6, s5, 13
    s_lshl_b32 s7, s4, 12
    s_add_u32 s6, s6, s7
    s_add_u32 s6, s6, s13
    v_add_u32 v11, s6, v1
    s_lshl_b32 s15, s3, 12
    s_lshl_b32 s6, s4, 11
    s_add_u32 s15, s15, s6
    s_add_u32 s15, s15, 11927552
    v_and_b32 v13, 1, v3
    v_lshlrev_b32 v123, 15, v13
    v_lshl_add_u32 v123, v2, 7, v123
    s_lshl_b32 s6, s5, 7
    s_lshl_b32 s7, s4, 17
    s_add_u32 s6, s6, s7
    s_add_u32 s6, s6, s13
    v_lshl_add_u32 v17, v22, 13, s6
    v_bfe_u32 v13, v2, 2, 1
    v_lshl_add_u32 v17, v13, 12, v17
    v_and_b32 v13, 3, v2
    v_lshl_add_u32 v17, v13, 4, v17
    s_mov_b32 s40, s38
    s_mov_b32 s41, s39
    s_mov_b32 s42, 12582912
    s_mov_b32 s43, 0x20000
    s_mov_b32 s56, s36
    s_mov_b32 s57, s37
    s_mov_b32 s58, 256
    s_mov_b32 s59, 0x20000
    buffer_load_dword v254, v24, s[40:43], 0 offen
    s_lshl_b32 s6, s5, 13
    s_lshl_b32 s7, s4, 12
    s_add_u32 s6, s6, s7
    s_add_u32 s6, s6, s13
    v_lshl_add_u32 v10, v14, 7, s6
    buffer_load_dword v253, v10, s[40:43], 0 offen
    s_waitcnt vmcnt(38)
    v_lshlrev_b32 v68, 16, v64
    v_lshlrev_b32 v69, 16, v66
    v_and_b32 v70, s28, v64
    v_and_b32 v71, s28, v66
    v_lshlrev_b32 v72, 16, v65
    v_lshlrev_b32 v73, 16, v67
    v_and_b32 v74, s28, v65
    v_and_b32 v75, s28, v67
    s_waitcnt vmcnt(31)
    v_lshlrev_b32 v128, 16, v224
    v_and_b32 v129, s28, v224
    v_lshlrev_b32 v130, 16, v225
    v_and_b32 v131, s28, v225
    v_lshlrev_b32 v132, 16, v226
    v_and_b32 v133, s28, v226
    v_lshlrev_b32 v134, 16, v227
    v_and_b32 v135, s28, v227
    v_lshlrev_b32 v136, 16, v228
    v_and_b32 v137, s28, v228
    v_lshlrev_b32 v138, 16, v229
    v_and_b32 v139, s28, v229
    v_lshlrev_b32 v140, 16, v230
    v_and_b32 v141, s28, v230
    v_pk_mul_f32 v[32:33], v[134:135], v[68:69]
    v_pk_fma_f32 v[32:33], v[132:133], v[70:71], v[32:33]
    v_pk_fma_f32 v[32:33], v[130:131], v[72:73], v[32:33]
    v_pk_fma_f32 v[32:33], v[128:129], v[74:75], v[32:33]
    v_pk_mul_f32 v[34:35], v[136:137], v[68:69]
    v_pk_fma_f32 v[34:35], v[134:135], v[70:71], v[34:35]
    v_pk_fma_f32 v[34:35], v[132:133], v[72:73], v[34:35]
    v_pk_fma_f32 v[34:35], v[130:131], v[74:75], v[34:35]
    v_pk_mul_f32 v[36:37], v[138:139], v[68:69]
    v_pk_fma_f32 v[36:37], v[136:137], v[70:71], v[36:37]
    v_pk_fma_f32 v[36:37], v[134:135], v[72:73], v[36:37]
    v_pk_fma_f32 v[36:37], v[132:133], v[74:75], v[36:37]
    v_pk_mul_f32 v[38:39], v[140:141], v[68:69]
    v_pk_fma_f32 v[38:39], v[138:139], v[70:71], v[38:39]
    v_pk_fma_f32 v[38:39], v[136:137], v[72:73], v[38:39]
    v_pk_fma_f32 v[38:39], v[134:135], v[74:75], v[38:39]
    s_waitcnt vmcnt(25)
    v_lshlrev_b32 v142, 16, v231
    v_and_b32 v143, s28, v231
    v_lshlrev_b32 v144, 16, v232
    v_and_b32 v145, s28, v232
    v_lshlrev_b32 v146, 16, v233
    v_and_b32 v147, s28, v233
    v_lshlrev_b32 v148, 16, v234
    v_and_b32 v149, s28, v234
    v_lshlrev_b32 v150, 16, v235
    v_and_b32 v151, s28, v235
    v_lshlrev_b32 v152, 16, v236
    v_and_b32 v153, s28, v236
    v_pk_mul_f32 v[40:41], v[142:143], v[68:69]
    v_pk_fma_f32 v[40:41], v[140:141], v[70:71], v[40:41]
    v_pk_fma_f32 v[40:41], v[138:139], v[72:73], v[40:41]
    v_pk_fma_f32 v[40:41], v[136:137], v[74:75], v[40:41]
    v_pk_mul_f32 v[42:43], v[144:145], v[68:69]
    v_pk_fma_f32 v[42:43], v[142:143], v[70:71], v[42:43]
    v_pk_fma_f32 v[42:43], v[140:141], v[72:73], v[42:43]
    v_pk_fma_f32 v[42:43], v[138:139], v[74:75], v[42:43]
    v_pk_mul_f32 v[44:45], v[146:147], v[68:69]
    v_pk_fma_f32 v[44:45], v[144:145], v[70:71], v[44:45]
    v_pk_fma_f32 v[44:45], v[142:143], v[72:73], v[44:45]
    v_pk_fma_f32 v[44:45], v[140:141], v[74:75], v[44:45]
    v_pk_mul_f32 v[46:47], v[148:149], v[68:69]
    v_pk_fma_f32 v[46:47], v[146:147], v[70:71], v[46:47]
    v_pk_fma_f32 v[46:47], v[144:145], v[72:73], v[46:47]
    v_pk_fma_f32 v[46:47], v[142:143], v[74:75], v[46:47]
    v_pk_mul_f32 v[48:49], v[150:151], v[68:69]
    v_pk_fma_f32 v[48:49], v[148:149], v[70:71], v[48:49]
    v_pk_fma_f32 v[48:49], v[146:147], v[72:73], v[48:49]
    v_pk_fma_f32 v[48:49], v[144:145], v[74:75], v[48:49]
    v_pk_mul_f32 v[50:51], v[152:153], v[68:69]
    v_pk_fma_f32 v[50:51], v[150:151], v[70:71], v[50:51]
    v_pk_fma_f32 v[50:51], v[148:149], v[72:73], v[50:51]
    v_pk_fma_f32 v[50:51], v[146:147], v[74:75], v[50:51]
    s_waitcnt vmcnt(19)
    v_lshlrev_b32 v154, 16, v237
    v_and_b32 v155, s28, v237
    v_lshlrev_b32 v156, 16, v238
    v_and_b32 v157, s28, v238
    v_lshlrev_b32 v158, 16, v239
    v_and_b32 v159, s28, v239
    v_lshlrev_b32 v160, 16, v240
    v_and_b32 v161, s28, v240
    v_lshlrev_b32 v162, 16, v241
    v_and_b32 v163, s28, v241
    v_lshlrev_b32 v164, 16, v242
    v_and_b32 v165, s28, v242
    v_pk_mul_f32 v[52:53], v[154:155], v[68:69]
    v_pk_fma_f32 v[52:53], v[152:153], v[70:71], v[52:53]
    v_pk_fma_f32 v[52:53], v[150:151], v[72:73], v[52:53]
    v_pk_fma_f32 v[52:53], v[148:149], v[74:75], v[52:53]
    v_pk_mul_f32 v[54:55], v[156:157], v[68:69]
    v_pk_fma_f32 v[54:55], v[154:155], v[70:71], v[54:55]
    v_pk_fma_f32 v[54:55], v[152:153], v[72:73], v[54:55]
    v_pk_fma_f32 v[54:55], v[150:151], v[74:75], v[54:55]
    v_pk_mul_f32 v[56:57], v[158:159], v[68:69]
    v_pk_fma_f32 v[56:57], v[156:157], v[70:71], v[56:57]
    v_pk_fma_f32 v[56:57], v[154:155], v[72:73], v[56:57]
    v_pk_fma_f32 v[56:57], v[152:153], v[74:75], v[56:57]
    v_pk_mul_f32 v[58:59], v[160:161], v[68:69]
    v_pk_fma_f32 v[58:59], v[158:159], v[70:71], v[58:59]
    v_pk_fma_f32 v[58:59], v[156:157], v[72:73], v[58:59]
    v_pk_fma_f32 v[58:59], v[154:155], v[74:75], v[58:59]
    v_pk_mul_f32 v[60:61], v[162:163], v[68:69]
    v_pk_fma_f32 v[60:61], v[160:161], v[70:71], v[60:61]
    v_pk_fma_f32 v[60:61], v[158:159], v[72:73], v[60:61]
    v_pk_fma_f32 v[60:61], v[156:157], v[74:75], v[60:61]
    v_pk_mul_f32 v[62:63], v[164:165], v[68:69]
    v_pk_fma_f32 v[62:63], v[162:163], v[70:71], v[62:63]
    v_pk_fma_f32 v[62:63], v[160:161], v[72:73], v[62:63]
    v_pk_fma_f32 v[62:63], v[158:159], v[74:75], v[62:63]
    s_waitcnt vmcnt(11)
    v_lshlrev_b32 v76, 16, v96
    v_and_b32 v77, s28, v96
    v_pk_mul_f32 v[32:33], v[32:33], v[76:77]
    v_lshlrev_b32 v78, 16, v97
    v_and_b32 v79, s28, v97
    v_pk_mul_f32 v[34:35], v[34:35], v[78:79]
    v_lshlrev_b32 v76, 16, v98
    v_and_b32 v77, s28, v98
    v_pk_mul_f32 v[36:37], v[36:37], v[76:77]
    v_lshlrev_b32 v78, 16, v99
    v_and_b32 v79, s28, v99
    v_pk_mul_f32 v[38:39], v[38:39], v[78:79]
    v_lshlrev_b32 v76, 16, v100
    v_and_b32 v77, s28, v100
    v_pk_mul_f32 v[40:41], v[40:41], v[76:77]
    v_lshlrev_b32 v78, 16, v101
    v_and_b32 v79, s28, v101
    v_pk_mul_f32 v[42:43], v[42:43], v[78:79]
    v_lshlrev_b32 v76, 16, v102
    v_and_b32 v77, s28, v102
    v_pk_mul_f32 v[44:45], v[44:45], v[76:77]
    v_lshlrev_b32 v78, 16, v103
    v_and_b32 v79, s28, v103
    v_pk_mul_f32 v[46:47], v[46:47], v[78:79]
    v_cvt_pk_bf16_f32 v80, v46, v44
    v_cvt_pk_bf16_f32 v81, v42, v40
    v_cvt_pk_bf16_f32 v82, v38, v36
    v_cvt_pk_bf16_f32 v83, v34, v32
    ds_write_b128 v8, v[80:83] offset:0
    v_cvt_pk_bf16_f32 v84, v47, v45
    v_cvt_pk_bf16_f32 v85, v43, v41
    v_cvt_pk_bf16_f32 v86, v39, v37
    v_cvt_pk_bf16_f32 v87, v35, v33
    ds_write_b128 v8, v[84:87] offset:64
    s_waitcnt vmcnt(3)
    v_lshlrev_b32 v76, 16, v104
    v_and_b32 v77, s28, v104
    v_pk_mul_f32 v[48:49], v[48:49], v[76:77]
    v_lshlrev_b32 v78, 16, v105
    v_and_b32 v79, s28, v105
    v_pk_mul_f32 v[50:51], v[50:51], v[78:79]
    v_lshlrev_b32 v76, 16, v106
    v_and_b32 v77, s28, v106
    v_pk_mul_f32 v[52:53], v[52:53], v[76:77]
    v_lshlrev_b32 v78, 16, v107
    v_and_b32 v79, s28, v107
    v_pk_mul_f32 v[54:55], v[54:55], v[78:79]
    v_lshlrev_b32 v76, 16, v108
    v_and_b32 v77, s28, v108
    v_pk_mul_f32 v[56:57], v[56:57], v[76:77]
    v_lshlrev_b32 v78, 16, v109
    v_and_b32 v79, s28, v109
    v_pk_mul_f32 v[58:59], v[58:59], v[78:79]
    v_lshlrev_b32 v76, 16, v110
    v_and_b32 v77, s28, v110
    v_pk_mul_f32 v[60:61], v[60:61], v[76:77]
    v_lshlrev_b32 v78, 16, v111
    v_and_b32 v79, s28, v111
    v_pk_mul_f32 v[62:63], v[62:63], v[78:79]
    v_cvt_pk_bf16_f32 v88, v62, v60
    v_cvt_pk_bf16_f32 v89, v58, v56
    v_cvt_pk_bf16_f32 v90, v54, v52
    v_cvt_pk_bf16_f32 v91, v50, v48
    ds_write_b128 v8, v[88:91] offset:16
    v_cvt_pk_bf16_f32 v92, v63, v61
    v_cvt_pk_bf16_f32 v93, v59, v57
    v_cvt_pk_bf16_f32 v94, v55, v53
    v_cvt_pk_bf16_f32 v95, v51, v49
    ds_write_b128 v8, v[92:95] offset:80
    ds_read_b128 v[128:131], v9 offset:0
    ds_read_b128 v[132:135], v9 offset:1152
    ds_read_b128 v[136:139], v9 offset:2304
    ds_read_b128 v[140:143], v9 offset:3456
    s_mov_b32 s6, 0
    s_waitcnt lgkmcnt(3)
    buffer_store_dwordx4 v[128:131], v11, s[40:43], s6 offen
    s_add_u32 s6, s6, 1024
    s_waitcnt lgkmcnt(2)
    buffer_store_dwordx4 v[132:135], v11, s[40:43], s6 offen
    s_add_u32 s6, s6, 1024
    s_waitcnt lgkmcnt(1)
    buffer_store_dwordx4 v[136:139], v11, s[40:43], s6 offen
    s_add_u32 s6, s6, 1024
    s_waitcnt lgkmcnt(0)
    buffer_store_dwordx4 v[140:143], v11, s[40:43], s6 offen
    buffer_load_dwordx2 v[114:115], v120, s[56:59], 0 offen sc1
    s_waitcnt vmcnt(0)
    s_mov_b32 s6, 100000
nl_interleave_layers__ssm_conv_h3__dense_activation_relu__prompt_kernel_1:
    v_readfirstlane_b32 s37, v115
    v_readfirstlane_b32 s36, v114
    s_cmp_lg_u32 s37, 0
    s_cbranch_scc1 nd_interleave_layers__ssm_conv_h3__dense_activation_relu__prompt_kernel_2
    s_sleep 1
    buffer_load_dwordx2 v[114:115], v120, s[56:59], 0 offen sc1
    s_waitcnt vmcnt(0)
    s_sub_u32 s6, s6, 1
    s_cmp_lg_u32 s6, 0
    s_cbranch_scc1 nl_interleave_layers__ssm_conv_h3__dense_activation_relu__prompt_kernel_1
nd_interleave_layers__ssm_conv_h3__dense_activation_relu__prompt_kernel_2:
    v_add_u32 v115, s25, v115
    buffer_store_dwordx2 v[114:115], v24, s[40:43], 0 offen
    v_subrev_u32 v24, 131072, v24
    buffer_store_dwordx2 v[114:115], v24, s[40:43], 0 offen sc1
    s_branch L_mid
L_b1:
    s_lshr_b32 s60, s2, 4
    s_and_b32 s61, s2, 15
    s_add_u32 s64, s5, 11
    s_and_b32 s64, s64, 31
    s_cmp_eq_u32 s4, 3
    s_cselect_b32 s62, s64, s61
    s_cselect_b32 s63, s3, s60
    s_movk_i32 s6, 2752
    s_cselect_b32 s6, 1024, s6
    s_cselect_b32 s7, 16, 4
    s_cselect_b32 s15, 4, 8
    s_cselect_b32 s45, 11, 12
    s_cselect_b32 s47, s64, s5
    s_movk_i32 s65, 2048
    s_cselect_b32 s65, 1048576, s65
    v_lshrrev_b32 v46, 5, v27
    v_and_b32 v51, 3, v22
    v_mad_u32_u24 v46, v46, s7, v51
    s_lshl_b32 s62, s62, 5
    v_add_u32 v46, s62, v46
    v_mul_lo_u32 v46, v46, s6
    s_mul_i32 s15, s15, s6
    s_lshl_b32 s63, s63, 7
    v_lshl_add_u32 v46, v21, 4, v46
    v_add_u32 v46, s63, v46
    s_cmp_lt_u32 s47, s45
    s_cselect_b32 s65, s65, 1073709056
    v_add_u32 v47, s65, v46
    s_lshl_b32 s46, s14, 13
    s_add_u32 s46, s46, 75776
    s_mov_b32 m0, s46
    s_mov_b32 s54, 1409024
    s_mov_b32 s55, 0x20000
    s_waitcnt lgkmcnt(0)
    s_cmp_eq_u32 s4, 3
    s_cselect_b32 s52, s32, s30
    s_cselect_b32 s53, s33, s31
    s_mov_b32 s6, 0
    buffer_load_dwordx4 v46, s[52:55], s6 offen lds
    s_add_u32 m0, m0, 1024
    s_add_u32 s6, s6, s15
    buffer_load_dwordx4 v46, s[52:55], s6 offen lds
    s_add_u32 m0, m0, 1024
    s_add_u32 s6, s6, s15
    buffer_load_dwordx4 v46, s[52:55], s6 offen lds
    s_add_u32 m0, m0, 1024
    s_add_u32 s6, s6, s15
    buffer_load_dwordx4 v46, s[52:55], s6 offen lds
    s_add_u32 m0, m0, 1024
    s_add_u32 s6, s6, s15
    s_mov_b32 s6, 0
    buffer_load_dwordx4 v47, s[52:55], s6 offen lds
    s_add_u32 m0, m0, 1024
    s_add_u32 s6, s6, s15
    buffer_load_dwordx4 v47, s[52:55], s6 offen lds
    s_add_u32 m0, m0, 1024
    s_add_u32 s6, s6, s15
    buffer_load_dwordx4 v47, s[52:55], s6 offen lds
    s_add_u32 m0, m0, 1024
    s_add_u32 s6, s6, s15
    buffer_load_dwordx4 v47, s[52:55], s6 offen lds
    s_add_u32 m0, m0, 1024
    s_add_u32 s6, s6, s15
    s_mov_b32 s56, s36
    s_mov_b32 s57, s37
    s_mov_b32 s58, 256
    s_mov_b32 s59, 0x20000
    s_xor_b32 s6, s4, 3
    s_or_b32 s6, s6, s2
    s_cmp_eq_u32 s6, 0
    s_cselect_b32 s6, 0, 2147418112
    s_lshl_b32 s67, s67, 8
    s_or_b32 s67, s67, 0x80000000
    v_mov_b32 v32, s66
    v_mov_b32 v33, s67
    v_lshl_add_u32 v34, v2, 3, s6
    buffer_store_dwordx2 v[32:33], v34, s[56:59], 0 offen sc1
    s_lshl_b32 s6, s8, 13
    s_lshl_b32 s7, s14, 12
    s_add_u32 s6, s6, s7
    v_add_u32 v44, s6, v1
    v_subrev_u32 v45, 16, v44
    v_cndmask_b32 v45, v45, v121, vcc
    s_mov_b32 s48, s24
    s_mov_b32 s49, s25
    s_mov_b32 s50, 2097152
    s_mov_b32 s51, 0x20000
    buffer_load_dwordx4 v[192:195], v45, s[48:51], 0 offen offset:0
    buffer_load_dwordx4 v[196:199], v44, s[48:51], 0 offen offset:0
    buffer_load_dwordx4 v[200:203], v44, s[48:51], 0 offen offset:1008
    buffer_load_dwordx4 v[204:207], v44, s[48:51], 0 offen offset:1024
    buffer_load_dwordx4 v[208:211], v44, s[48:51], 0 offen offset:2032
    buffer_load_dwordx4 v[212:215], v44, s[48:51], 0 offen offset:2048
    buffer_load_dwordx4 v[216:219], v44, s[48:51], 0 offen offset:3056
    buffer_load_dwordx4 v[220:223], v44, s[48:51], 0 offen offset:3072
    s_lshl_b32 s63, s60, 16
    s_lshl_b32 s6, s61, 10
    s_add_u32 s63, s63, s6
    s_add_u32 s63, s63, 8388608
    s_mul_i32 s7, s3, 43
    s_add_u32 s7, s7, s64
    s_lshl_b32 s7, s7, 12
    s_add_u32 s7, s7, 9830400
    s_cmp_eq_u32 s4, 3
    s_cselect_b32 s63, s7, s63
    s_mov_b32 s31, 16384
    s_cselect_b32 s31, 1024, s31
    s_cselect_b32 s60, 4, 3
    s_cselect_b32 s61, 8, 32
    s_mov_b32 s44, 1048576
    s_cselect_b32 s44, 131072, s44
    s_cmp_lt_u32 s47, s45
    s_cselect_b32 s44, s44, 1073709056
    s_mov_b32 s40, s38
    s_mov_b32 s41, s39
    s_mov_b32 s42, 12582912
    s_mov_b32 s43, 0x20000
    s_lshl_b32 s6, s14, 12
    s_lshl_b32 s7, s8, 4
    s_add_u32 s6, s6, s7
    s_add_u32 s24, s6, 11730944
    buffer_load_dword v253, v120, s[40:43], s24 offen
    v_lshrrev_b32 v52, 2, v2
    v_lshl_add_u32 v51, v3, 3, v52
    v_lshlrev_b32 v51, 7, v51
    v_and_b32 v52, 3, v2
    v_lshlrev_b32 v52, s60, v52
    v_add3_u32 v108, v51, v52, s46
    v_add_u32 v109, s61, v108
    v_add_u32 v110, s63, v1
    v_add_u32 v111, s44, v110
    v_mov_b32 v248, 0
    v_mov_b32 v249, 0
    v_mov_b32 v250, 0
    v_mov_b32 v251, 0
    v_mul_u32_u24 v13, 4160, v2
    ds_write_b128 v13, v[248:251] offset:9216
    v_and_b32 v13, 31, v27
    v_lshlrev_b32 v13, 4, v13
    ds_write_b128 v13, v[248:251] offset:0
    ds_write_b128 v13, v[248:251] offset:4608
    s_mul_i32 s6, s14, 33280
    s_add_u32 s6, s6, 9232
    v_add_u32 v6, s6, v1
    s_lshl_b32 s6, s5, 1
    s_add_u32 s6, s6, s14
    s_mul_i32 s6, s6, 7168
    s_add_u32 s6, s6, s13
    s_add_u32 s6, s6, 262144
    v_lshl_add_u32 v125, v27, 7, s6
    v_cmp_gt_u32 vcc, 56, v27
    s_nop 1
    v_cndmask_b32 v125, v121, v125, vcc
    buffer_load_dword v254, v24, s[40:43], 0 offen
    s_waitcnt vmcnt(11)
    ds_read_b64_tr_b16 v[64:65], v108 offset:0
    ds_read_b64_tr_b16 v[66:67], v108 offset:512
    ds_read_b64_tr_b16 v[68:69], v109 offset:0
    ds_read_b64_tr_b16 v[70:71], v109 offset:512
    ds_read_b64_tr_b16 v[72:73], v108 offset:64
    ds_read_b64_tr_b16 v[74:75], v108 offset:576
    ds_read_b64_tr_b16 v[76:77], v109 offset:64
    ds_read_b64_tr_b16 v[78:79], v109 offset:576
    ds_read_b64_tr_b16 v[80:81], v108 offset:4096
    ds_read_b64_tr_b16 v[82:83], v108 offset:4608
    ds_read_b64_tr_b16 v[84:85], v109 offset:4096
    ds_read_b64_tr_b16 v[86:87], v109 offset:4608
    ds_read_b64_tr_b16 v[88:89], v108 offset:4160
    ds_read_b64_tr_b16 v[90:91], v108 offset:4672
    ds_read_b64_tr_b16 v[92:93], v109 offset:4160
    ds_read_b64_tr_b16 v[94:95], v109 offset:4672
    s_waitcnt lgkmcnt(8)
    s_mul_i32 s6, s31, 0
    buffer_store_dwordx4 v[64:67], v110, s[40:43], s6 offen sc1
    s_mul_i32 s6, s31, 1
    buffer_store_dwordx4 v[68:71], v110, s[40:43], s6 offen sc1
    s_mul_i32 s6, s31, 2
    buffer_store_dwordx4 v[72:75], v110, s[40:43], s6 offen sc1
    s_mul_i32 s6, s31, 3
    buffer_store_dwordx4 v[76:79], v110, s[40:43], s6 offen sc1
    s_waitcnt lgkmcnt(0)
    s_mul_i32 s6, s31, 0
    buffer_store_dwordx4 v[80:83], v111, s[40:43], s6 offen sc1
    s_mul_i32 s6, s31, 1
    buffer_store_dwordx4 v[84:87], v111, s[40:43], s6 offen sc1
    s_mul_i32 s6, s31, 2
    buffer_store_dwordx4 v[88:91], v111, s[40:43], s6 offen sc1
    s_mul_i32 s6, s31, 3
    buffer_store_dwordx4 v[92:95], v111, s[40:43], s6 offen sc1
    buffer_load_dwordx2 v[114:115], v120, s[56:59], 0 offen sc1
    s_waitcnt vmcnt(17)
    v_mov_b32 v144, v193
    v_mov_b32 v145, v194
    v_mov_b32 v146, v195
    v_mov_b32 v147, v196
    v_mov_b32 v148, v197
    v_mov_b32 v149, v198
    v_alignbit_b32 v150, v193, v192, 16
    v_alignbit_b32 v151, v194, v193, 16
    v_alignbit_b32 v152, v195, v194, 16
    v_alignbit_b32 v153, v196, v195, 16
    v_alignbit_b32 v154, v197, v196, 16
    v_alignbit_b32 v155, v198, v197, 16
    v_alignbit_b32 v156, v194, v193, 16
    v_alignbit_b32 v157, v195, v194, 16
    v_alignbit_b32 v158, v196, v195, 16
    v_alignbit_b32 v159, v197, v196, 16
    v_alignbit_b32 v160, v198, v197, 16
    v_alignbit_b32 v161, v199, v198, 16
    ds_write_b128 v6, v[150:153] offset:0
    ds_write_b128 v6, v[144:147] offset:4160
    ds_write_b128 v6, v[156:159] offset:8320
    ds_write_b128 v6, v[194:197] offset:12480
    ds_write_b128 v6, v[152:155] offset:16640
    ds_write_b128 v6, v[146:149] offset:20800
    ds_write_b128 v6, v[158:161] offset:24960
    ds_write_b128 v6, v[196:199] offset:29120
    s_waitcnt vmcnt(15)
    v_mov_b32 v162, v201
    v_mov_b32 v163, v202
    v_mov_b32 v164, v203
    v_mov_b32 v165, v204
    v_mov_b32 v166, v205
    v_mov_b32 v167, v206
    v_alignbit_b32 v168, v201, v200, 16
    v_alignbit_b32 v169, v202, v201, 16
    v_alignbit_b32 v170, v203, v202, 16
    v_alignbit_b32 v171, v204, v203, 16
    v_alignbit_b32 v172, v205, v204, 16
    v_alignbit_b32 v173, v206, v205, 16
    v_alignbit_b32 v174, v202, v201, 16
    v_alignbit_b32 v175, v203, v202, 16
    v_alignbit_b32 v176, v204, v203, 16
    v_alignbit_b32 v177, v205, v204, 16
    v_alignbit_b32 v178, v206, v205, 16
    v_alignbit_b32 v179, v207, v206, 16
    ds_write_b128 v6, v[168:171] offset:1024
    ds_write_b128 v6, v[162:165] offset:5184
    ds_write_b128 v6, v[174:177] offset:9344
    ds_write_b128 v6, v[202:205] offset:13504
    ds_write_b128 v6, v[170:173] offset:17664
    ds_write_b128 v6, v[164:167] offset:21824
    ds_write_b128 v6, v[176:179] offset:25984
    ds_write_b128 v6, v[204:207] offset:30144
    s_waitcnt vmcnt(13) lgkmcnt(8)
    v_mov_b32 v144, v209
    v_mov_b32 v145, v210
    v_mov_b32 v146, v211
    v_mov_b32 v147, v212
    v_mov_b32 v148, v213
    v_mov_b32 v149, v214
    v_alignbit_b32 v150, v209, v208, 16
    v_alignbit_b32 v151, v210, v209, 16
    v_alignbit_b32 v152, v211, v210, 16
    v_alignbit_b32 v153, v212, v211, 16
    v_alignbit_b32 v154, v213, v212, 16
    v_alignbit_b32 v155, v214, v213, 16
    v_alignbit_b32 v156, v210, v209, 16
    v_alignbit_b32 v157, v211, v210, 16
    v_alignbit_b32 v158, v212, v211, 16
    v_alignbit_b32 v159, v213, v212, 16
    v_alignbit_b32 v160, v214, v213, 16
    v_alignbit_b32 v161, v215, v214, 16
    ds_write_b128 v6, v[150:153] offset:2048
    ds_write_b128 v6, v[144:147] offset:6208
    ds_write_b128 v6, v[156:159] offset:10368
    ds_write_b128 v6, v[210:213] offset:14528
    ds_write_b128 v6, v[152:155] offset:18688
    ds_write_b128 v6, v[146:149] offset:22848
    ds_write_b128 v6, v[158:161] offset:27008
    ds_write_b128 v6, v[212:215] offset:31168
    s_waitcnt vmcnt(0)
    s_mov_b32 s6, 100000
nl_interleave_layers__ssm_conv_h3__dense_activation_relu__prompt_kernel_3:
    v_readfirstlane_b32 s37, v115
    v_readfirstlane_b32 s36, v114
    s_cmp_lg_u32 s37, 0
    s_cbranch_scc1 nd_interleave_layers__ssm_conv_h3__dense_activation_relu__prompt_kernel_4
    s_sleep 1
    buffer_load_dwordx2 v[114:115], v120, s[56:59], 0 offen sc1
    s_waitcnt vmcnt(0)
    s_sub_u32 s6, s6, 1
    s_cmp_lg_u32 s6, 0
    s_cbranch_scc1 nl_interleave_layers__ssm_conv_h3__dense_activation_relu__prompt_kernel_3
nd_interleave_layers__ssm_conv_h3__dense_activation_relu__prompt_kernel_4:
    s_mov_b64 exec, 1
    buffer_store_dwordx2 v[114:115], v120, s[40:43], s24 offen sc1
    s_mov_b64 exec, -1
    s_waitcnt lgkmcnt(8)
    v_mov_b32 v162, v217
    v_mov_b32 v163, v218
    v_mov_b32 v164, v219
    v_mov_b32 v165, v220
    v_mov_b32 v166, v221
    v_mov_b32 v167, v222
    v_alignbit_b32 v168, v217, v216, 16
    v_alignbit_b32 v169, v218, v217, 16
    v_alignbit_b32 v170, v219, v218, 16
    v_alignbit_b32 v171, v220, v219, 16
    v_alignbit_b32 v172, v221, v220, 16
    v_alignbit_b32 v173, v222, v221, 16
    v_alignbit_b32 v174, v218, v217, 16
    v_alignbit_b32 v175, v219, v218, 16
    v_alignbit_b32 v176, v220, v219, 16
    v_alignbit_b32 v177, v221, v220, 16
    v_alignbit_b32 v178, v222, v221, 16
    v_alignbit_b32 v179, v223, v222, 16
    ds_write_b128 v6, v[168:171] offset:3072
    ds_write_b128 v6, v[162:165] offset:7232
    ds_write_b128 v6, v[174:177] offset:11392
    ds_write_b128 v6, v[218:221] offset:15552
    ds_write_b128 v6, v[170:173] offset:19712
    ds_write_b128 v6, v[164:167] offset:23872
    ds_write_b128 v6, v[176:179] offset:28032
    ds_write_b128 v6, v[220:223] offset:32192
L_mid:
    s_lshl_b32 s6, s8, 2
    s_load_dword s30, s[26:27], s6
    v_cmp_eq_u32 vcc, 0, v0
    s_lshl_b32 s6, s11, 2
    s_add_u32 s6, s6, s12
    v_mov_b32 v7, s6
    v_cndmask_b32 v7, v121, v7, vcc
    s_lshl_b32 s6, s8, 7
    s_add_u32 s6, s6, 11993088
    v_mov_b32 v29, s6
    v_cndmask_b32 v29, v121, v29, vcc
    s_mov_b32 s44, s34
    s_mov_b32 s45, s35
    s_mov_b32 s46, 2097152
    s_mov_b32 s47, 0x20000
    s_mov_b32 s32, s16
    s_mov_b32 s33, s17
    s_mov_b32 s34, 2097152
    s_mov_b32 s35, 0x20000
    s_add_u32 s48, s11, 0
    s_and_b32 s48, s48, 7
    s_lshl_b32 s48, s48, 11
    s_add_u32 s49, s11, 1
    s_and_b32 s49, s49, 7
    s_lshl_b32 s49, s49, 11
    s_add_u32 s50, s11, 2
    s_and_b32 s50, s50, 7
    s_lshl_b32 s50, s50, 11
    s_add_u32 s51, s11, 3
    s_and_b32 s51, s51, 7
    s_lshl_b32 s51, s51, 11
    s_add_u32 s52, s11, 4
    s_and_b32 s52, s52, 7
    s_lshl_b32 s52, s52, 11
    s_add_u32 s53, s11, 5
    s_and_b32 s53, s53, 7
    s_lshl_b32 s53, s53, 11
    s_add_u32 s54, s11, 6
    s_and_b32 s54, s54, 7
    s_lshl_b32 s54, s54, 11
    s_add_u32 s55, s11, 7
    s_and_b32 s55, s55, 7
    s_lshl_b32 s55, s55, 11
    s_getreg_b32 s25, hwreg(HW_REG_XCC_ID)
    s_and_b32 s25, s25, 15
    s_lshl_b32 s6, s10, 6
    s_lshl_b32 s7, s4, 4
    s_add_u32 s13, s6, s7
    s_mov_b32 s16, s10
    s_mov_b32 s17, s11
    s_mov_b32 s28, 0xffff0000
    s_mov_b32 s29, 0x3b000000
    s_mov_b32 s60, 0x22222222
    s_mov_b32 s61, 0x22222222
    s_mov_b32 s62, 0x44444444
    s_mov_b32 s63, 0x44444444
    s_mov_b32 s64, 0x88888888
    s_mov_b32 s65, 0x88888888
    s_mov_b32 s66, 0xf0000f
    s_mov_b32 s67, 0xf0000f00
    v_mov_b32 v15, 1.0
    v_and_b32 v124, 3, v2
    s_lshr_b32 s18, s4, 1
    s_mov_b32 s19, s14
    v_add_u32 v0, s13, v2
    v_lshlrev_b32 v25, 10, v0
    v_lshl_add_u32 v25, v3, 4, v25
    s_lshl_b32 s6, s17, 7
    v_add_u32 v25, s6, v25
    v_mul_u32_u24 v20, 4160, v21
    v_lshrrev_b32 v13, 3, v2
    v_sub_u32 v13, v13, v3
    v_lshl_add_u32 v20, v13, 4, v20
    s_mul_i32 s6, s18, 33280
    s_lshl_b32 s7, s19, 8
    s_add_u32 s6, s6, s7
    s_add_u32 s6, s6, 9264
    v_add_u32 v20, s6, v20
    s_mul_i32 s6, s18, 4608
    v_lshlrev_b32 v4, 5, v2
    v_lshl_add_u32 v14, v3, 4, v4
    s_add_u32 s10, s6, 288
    s_sub_u32 s10, s10, s7
    v_add_u32 v14, s10, v14
    s_lshl_b32 s7, s19, 9
    v_xor_b32 v13, 1, v3
    v_lshl_add_u32 v5, v13, 3, v4
    s_add_u32 s10, s6, s7
    s_add_u32 s10, s10, 512
    v_add_u32 v5, s10, v5
    s_lshl_b32 s10, s8, 1
    s_add_u32 s10, s10, s18
    s_bfe_u32 s11, s10, 0x10001
    s_bfe_u32 s6, s10, 0x10003
    s_lshl_b32 s6, s6, 1
    s_or_b32 s11, s11, s6
    v_xor_b32 v8, s11, v124
    v_lshlrev_b32 v8, 5, v8
    v_lshrrev_b32 v13, 1, v3
    v_lshl_add_u32 v8, v13, 4, v8
    v_lshrrev_b32 v13, 2, v2
    v_lshl_add_u32 v8, v13, 16, v8
    v_and_b32 v13, 1, v3
    v_lshl_add_u32 v8, v13, 19, v8
    s_lshl_b32 s10, s10, 7
    s_lshl_b32 s11, s19, 18
    s_add_u32 s10, s10, s11
    v_add_u32 v8, s10, v8
    s_lshl_b32 s10, s4, 13
    s_add_u32 s10, s10, 9216
    v_add_u32 v9, s10, v1
    s_lshl_b32 s10, s18, 14
    s_lshl_b32 s11, s19, 10
    s_add_u32 s10, s10, s11
    s_add_u32 s10, s10, 9216
    v_add_u32 v10, s10, v1
    v_lshlrev_b32 v12, 2, v21
    s_lshr_b32 s10, s17, 1
    s_and_b32 s11, s17, 1
    s_mul_i32 s7, s10, 11
    s_lshl_b32 s56, s11, 2
    s_add_u32 s56, s56, s7
    s_add_u32 s56, s56, s4
    s_add_u32 s57, s7, 8
    s_add_u32 s57, s57, s11
    s_add_u32 s7, s7, 10
    s_cmp_lt_u32 s4, 2
    s_cselect_b32 s57, s57, s7
    s_cselect_b32 s58, s4, s11
    s_cmp_lt_u32 s57, 43
    s_cselect_b32 s59, 1, 0
    s_cmp_lt_u32 s4, 3
    s_cselect_b32 s59, s59, 0
    s_lshl_b32 s24, s57, 1
    s_add_u32 s24, s24, s58
    s_lshl_b32 s6, s56, 15
    s_add_u32 s6, s6, 8388608
    v_add_u32 v18, s6, v1
    v_add_u32 v47, 16384, v18
    s_lshl_b32 s7, s24, 14
    s_add_u32 s7, s7, 8388608
    s_cmp_eq_u32 s59, 1
    s_cselect_b32 s7, s7, 2147418112
    v_add_u32 v19, s7, v1
    s_mul_i32 s14, s4, 16384
    s_add_u32 s14, s14, 98304
    v_add_u32 v30, s14, v1
    s_cmp_eq_u32 s4, 3
    s_cselect_b32 s7, 2147418112, 0
    v_add_u32 v26, s7, v1
    s_mul_i32 s5, s17, 176128
    s_add_u32 s5, s5, 9830400
    s_lshl_b32 s6, s16, 13
    s_lshl_b32 s7, s4, 7
    s_add_u32 s6, s6, s7
    s_add_u32 s6, s6, 12058624
    v_lshl_add_u32 v13, v2, 3, s6
    v_lshl_add_u32 v11, v3, 11, v13
    s_lshl_b32 s6, s17, 10
    v_add_u32 v13, s6, v13
    v_cndmask_b32 v6, v121, v13, s[66:67]
    s_cmp_ge_u32 s4, 2
    s_cbranch_scc1 L_b2
    s_mov_b32 s20, s36
    s_add_u32 s21, s37, s25
    s_mov_b32 s6, 100000
    s_sub_u32 s22, s15, 131072
L_tp:
    buffer_load_dwordx2 v[96:97], v123, s[40:43], s15 offen sc1
    s_waitcnt vmcnt(0)
    v_cmp_ne_u64 vcc, s[20:21], v[96:97]
    s_cbranch_vccz L_tdone
    s_mov_b64 exec, vcc
    s_sub_u32 s6, s6, 1
    s_cmp_eq_u32 s6, 0
    s_cbranch_scc1 L_tdone
    s_and_b32 s7, s6, 15
    s_cbranch_scc1 L_tp
    buffer_load_dwordx2 v[96:97], v123, s[40:43], s22 offen sc1
    s_waitcnt vmcnt(0)
    v_subrev_u32 v98, s37, v97
    v_cmp_eq_u32 s[10:11], s36, v96
    v_cmp_gt_u32 vcc, 16, v98
    s_nop 0
    s_and_b64 s[10:11], s[10:11], vcc
    v_cmp_ne_u32 vcc, s21, v97
    s_nop 0
    s_and_b64 vcc, vcc, s[10:11]
    s_cbranch_scc0 L_tp
    s_mov_b64 s[68:69], exec
    s_mov_b64 exec, -1
    v_and_b32 v99, 1, v2
    v_lshlrev_b32 v99, 15, v99
    s_lshl_b32 s7, s8, 7
    s_add_u32 s23, s7, 11927552
    s_mov_b32 s6, 100000
    s_add_u32 s7, s37, 0
np_interleave_layers__ssm_conv_h3__dense_activation_relu__prompt_kernel_5:
    buffer_load_dwordx2 v[96:97], v99, s[40:43], s23 offen sc1
    s_waitcnt vmcnt(0)
    v_subrev_u32 v97, s7, v97
    v_cmp_ne_u32 s[10:11], s36, v96
    v_cmp_le_u32 vcc, 64, v97
    s_nop 0
    s_or_b64 vcc, vcc, s[10:11]
    s_cbranch_scc0 nd_interleave_layers__ssm_conv_h3__dense_activation_relu__prompt_kernel_6
    s_mov_b64 exec, vcc
    s_sleep 1
    s_sub_u32 s6, s6, 1
    s_cmp_lg_u32 s6, 0
    s_cbranch_scc1 np_interleave_layers__ssm_conv_h3__dense_activation_relu__prompt_kernel_5
nd_interleave_layers__ssm_conv_h3__dense_activation_relu__prompt_kernel_6:
    s_mov_b64 exec, -1
    buffer_wbl2 sc1
    s_waitcnt vmcnt(0)
    s_sub_u32 s23, s23, 65536
    buffer_store_dwordx2 v[114:115], v120, s[40:43], s23 offen sc1
    v_lshlrev_b32 v99, 7, v2
    s_sub_u32 s22, s15, 65536
    s_mov_b32 s6, 100000
    s_mov_b64 exec, s[68:69]
L_ts:
    buffer_load_dwordx2 v[96:97], v123, s[40:43], s15 offen sc1
    buffer_load_dwordx2 v[100:101], v99, s[40:43], s22 offen sc1
    s_waitcnt vmcnt(0)
    v_subrev_u32 v98, s37, v101
    v_cmp_ne_u32 s[10:11], s36, v100
    v_cmp_le_u32 vcc, 16, v98
    s_nop 0
    s_or_b64 s[10:11], s[10:11], vcc
    v_cmp_ne_u64 vcc, s[20:21], v[96:97]
    s_nop 0
    s_and_b64 vcc, vcc, s[10:11]
    s_cbranch_scc0 L_tacq
    s_mov_b64 exec, vcc
    s_sleep 1
    s_sub_u32 s6, s6, 1
    s_cmp_lg_u32 s6, 0
    s_cbranch_scc1 L_ts
L_tacq:
    buffer_inv sc1
    s_waitcnt vmcnt(0)
L_tdone:
    s_mov_b64 exec, -1
    s_lshl_b32 s11, s4, 11
    s_add_u32 m0, s11, 512
    s_mov_b32 s10, 0
    buffer_load_dwordx4 v17, s[40:43], s10 offen sc1 lds
    s_add_u32 m0, s11, 5120
    s_mov_b32 s10, 64
    buffer_load_dwordx4 v17, s[40:43], s10 offen sc1 lds
    s_add_u32 m0, s11, 1536
    s_mov_b32 s10, 65536
    buffer_load_dwordx4 v17, s[40:43], s10 offen sc1 lds
    s_add_u32 m0, s11, 6144
    s_mov_b32 s10, 65600
    buffer_load_dwordx4 v17, s[40:43], s10 offen sc1 lds
L_b2:
    s_waitcnt lgkmcnt(0)
    s_lshl_b32 s6, s30, 16
    s_and_b32 s7, s30, 0xffff0000
    s_cmp_eq_u32 s18, 1
    s_cselect_b32 s30, s7, s6
    s_barrier
    ds_read_b128 a[192:195], v20 offset:0
    buffer_load_dwordx4 v[32:35], v25, s[32:35], 0 offen offset:0
    ds_read_b128 a[196:199], v20 offset:64
    ds_read_b128 a[200:203], v20 offset:128
    ds_read_b128 a[204:207], v20 offset:192
    ds_read_b128 a[208:211], v20 offset:512
    ds_read_b128 a[212:215], v20 offset:576
    ds_read_b128 a[216:219], v20 offset:640
    ds_read_b128 a[220:223], v20 offset:704
    ds_read_b128 a[224:227], v20 offset:1024
    ds_read_b128 a[228:231], v20 offset:1088
    ds_read_b128 a[232:235], v20 offset:1152
    ds_read_b128 a[236:239], v20 offset:1216
    ds_read_b128 a[240:243], v20 offset:1536
    ds_read_b128 a[244:247], v20 offset:1600
    ds_read_b128 a[248:251], v20 offset:1664
    ds_read_b128 a[252:255], v20 offset:1728
    ds_read_b128 v[192:195], v20 offset:2048
    buffer_load_dwordx4 v[36:39], v25, s[32:35], 0 offen offset:64
    ds_read_b128 v[196:199], v20 offset:2112
    ds_read_b128 v[200:203], v20 offset:2176
    ds_read_b128 v[204:207], v20 offset:2240
    ds_read_b128 v[208:211], v20 offset:2560
    ds_read_b128 v[212:215], v20 offset:2624
    ds_read_b128 v[216:219], v20 offset:2688
    ds_read_b128 v[220:223], v20 offset:2752
    ds_read_b128 v[224:227], v20 offset:3072
    ds_read_b128 v[228:231], v20 offset:3136
    ds_read_b128 v[232:235], v20 offset:3200
    ds_read_b128 v[236:239], v20 offset:3264
    ds_read_b128 v[240:243], v20 offset:3584
    ds_read_b128 v[244:247], v20 offset:3648
    ds_read_b128 v[248:251], v20 offset:3712
    ds_read_b128 v[252:255], v20 offset:3776
    v_mov_b32 v42, v125
    v_mov_b32 v31, v125
    v_mov_b32 v60, 0x3f803f80
    v_mov_b32 v61, 0x3f803f80
    v_mov_b32 v62, 0x3f803f80
    v_mov_b32 v63, 0x3f803f80
    s_waitcnt vmcnt(2) lgkmcnt(0)
    s_barrier
    v_lshlrev_b32 v40, 5, v12
    s_lshl_b32 s6, s16, 10
    s_add_u32 s6, s6, 11927552
    buffer_load_dwordx2 v[40:41], v40, s[40:43], s6 offen sc1
    ds_read_b128 v[128:131], v14 offset:192
    ds_read_b128 v[132:135], v14 offset:128
    ds_read_b128 v[136:139], v14 offset:64
    ds_read_b128 v[140:143], v14 offset:0
    ds_read_b64 v[160:161], v5 offset:0
    ds_read_b64 v[162:163], v5 offset:1024
    ds_read_b64 v[164:165], v5 offset:2048
    ds_read_b64 v[166:167], v5 offset:3072
    buffer_load_dword v43, v42, s[40:43], 0 offen
    s_waitcnt lgkmcnt(4)
    v_mfma_f32_16x16x32_bf16 v[96:99], a[192:195], v[128:131], 0
    v_mfma_f32_16x16x32_bf16 v[96:99], a[196:199], v[132:135], v[96:99]
    ds_read_b128 v[144:147], v14 offset:704
    ds_read_b128 v[148:151], v14 offset:640
    v_mfma_f32_16x16x32_bf16 v[96:99], a[200:203], v[136:139], v[96:99]
    ds_read_b128 v[152:155], v14 offset:576
    v_mfma_f32_16x16x32_bf16 v[96:99], a[204:207], v[140:143], v[96:99]
    ds_read_b128 v[156:159], v14 offset:512
    s_add_u32 s94, s17, 0
    v_mfma_f32_16x16x32_bf16 v[100:103], a[208:211], v[128:131], 0
    s_bfe_u32 s23, s94, 0x20001
    v_mfma_f32_16x16x32_bf16 v[100:103], a[212:215], v[132:135], v[100:103]
    s_mul_i32 s23, s23, 11
    s_and_b32 s94, s94, 1
    v_mfma_f32_16x16x32_bf16 v[100:103], a[216:219], v[136:139], v[100:103]
    s_lshl2_add_u32 s94, s94, s23
    v_mfma_f32_16x16x32_bf16 v[100:103], a[220:223], v[140:143], v[100:103]
    s_add_u32 s94, s94, s4
    v_mfma_f32_16x16x32_bf16 v[104:107], a[224:227], v[128:131], 0
    s_lshl_b32 s94, s94, 10
    s_add_u32 s95, s17, 1
    v_mfma_f32_16x16x32_bf16 v[104:107], a[228:231], v[132:135], v[104:107]
    s_bfe_u32 s23, s95, 0x20001
    v_mfma_f32_16x16x32_bf16 v[104:107], a[232:235], v[136:139], v[104:107]
    s_mul_i32 s23, s23, 11
    s_and_b32 s95, s95, 1
    v_mfma_f32_16x16x32_bf16 v[104:107], a[236:239], v[140:143], v[104:107]
    s_lshl2_add_u32 s95, s95, s23
    v_mfma_f32_16x16x32_bf16 v[108:111], a[240:243], v[128:131], 0
    s_add_u32 s95, s95, s4
    s_lshl_b32 s95, s95, 10
    v_mfma_f32_16x16x32_bf16 v[108:111], a[244:247], v[132:135], v[108:111]
    s_add_u32 s96, s17, 2
    v_mfma_f32_16x16x32_bf16 v[108:111], a[248:251], v[136:139], v[108:111]
    s_bfe_u32 s23, s96, 0x20001
    v_mfma_f32_16x16x32_bf16 v[108:111], a[252:255], v[140:143], v[108:111]
    s_mul_i32 s23, s23, 11
    s_and_b32 s96, s96, 1
    v_mfma_f32_16x16x32_bf16 v[112:115], v[192:195], v[128:131], 0
    s_lshl2_add_u32 s96, s96, s23
    v_mfma_f32_16x16x32_bf16 v[112:115], v[196:199], v[132:135], v[112:115]
    s_add_u32 s96, s96, s4
    s_lshl_b32 s96, s96, 10
    v_mfma_f32_16x16x32_bf16 v[112:115], v[200:203], v[136:139], v[112:115]
    s_add_u32 s97, s17, 3
    v_mfma_f32_16x16x32_bf16 v[112:115], v[204:207], v[140:143], v[112:115]
    s_bfe_u32 s23, s97, 0x20001
    v_mfma_f32_16x16x32_bf16 v[116:119], v[208:211], v[128:131], 0
    s_mul_i32 s23, s23, 11
    s_and_b32 s97, s97, 1
    v_mfma_f32_16x16x32_bf16 v[116:119], v[212:215], v[132:135], v[116:119]
    s_lshl2_add_u32 s97, s97, s23
    v_mfma_f32_16x16x32_bf16 v[116:119], v[216:219], v[136:139], v[116:119]
    s_add_u32 s97, s97, s4
    s_lshl_b32 s97, s97, 10
    v_mfma_f32_16x16x32_bf16 v[116:119], v[220:223], v[140:143], v[116:119]
    s_add_u32 s98, s17, 4
    v_mfma_f32_16x16x32_bf16 v[120:123], v[224:227], v[128:131], 0
    s_bfe_u32 s23, s98, 0x20001
    s_mul_i32 s23, s23, 11
    v_mfma_f32_16x16x32_bf16 v[120:123], v[228:231], v[132:135], v[120:123]
    s_and_b32 s98, s98, 1
    v_mfma_f32_16x16x32_bf16 v[120:123], v[232:235], v[136:139], v[120:123]
    s_lshl2_add_u32 s98, s98, s23
    v_mfma_f32_16x16x32_bf16 v[120:123], v[236:239], v[140:143], v[120:123]
    s_add_u32 s98, s98, s4
    s_lshl_b32 s98, s98, 10
    v_mfma_f32_16x16x32_bf16 v[124:127], v[240:243], v[128:131], 0
    s_add_u32 s99, s17, 5
    v_mfma_f32_16x16x32_bf16 v[124:127], v[244:247], v[132:135], v[124:127]
    s_bfe_u32 s23, s99, 0x20001
    s_mul_i32 s23, s23, 11
    v_mfma_f32_16x16x32_bf16 v[124:127], v[248:251], v[136:139], v[124:127]
    s_and_b32 s99, s99, 1
    v_mfma_f32_16x16x32_bf16 v[124:127], v[252:255], v[140:143], v[124:127]
    s_lshl2_add_u32 s99, s99, s23
    s_waitcnt lgkmcnt(0)
    v_mfma_f32_16x16x32_bf16 v[100:103], a[192:195], v[144:147], v[100:103]
    v_mfma_f32_16x16x32_bf16 v[100:103], a[196:199], v[148:151], v[100:103]
    ds_read_b128 v[128:131], v14 offset:1216
    v_mfma_f32_16x16x32_bf16 v[100:103], a[200:203], v[152:155], v[100:103]
    s_add_u32 s99, s99, s4
    v_mfma_f32_16x16x32_bf16 v[100:103], a[204:207], v[156:159], v[100:103]
    s_lshl_b32 s99, s99, 10
    v_mfma_f32_16x16x32_bf16 v[104:107], a[208:211], v[144:147], v[104:107]
    s_add_u32 s100, s17, 6
    v_mfma_f32_16x16x32_bf16 v[104:107], a[212:215], v[148:151], v[104:107]
    s_bfe_u32 s23, s100, 0x20001
    v_mfma_f32_16x16x32_bf16 v[104:107], a[216:219], v[152:155], v[104:107]
    s_mul_i32 s23, s23, 11
    v_mfma_f32_16x16x32_bf16 v[104:107], a[220:223], v[156:159], v[104:107]
    ds_read_b128 v[132:135], v14 offset:1152
    v_mfma_f32_16x16x32_bf16 v[108:111], a[224:227], v[144:147], v[108:111]
    s_and_b32 s100, s100, 1
    v_mfma_f32_16x16x32_bf16 v[108:111], a[228:231], v[148:151], v[108:111]
    s_lshl2_add_u32 s100, s100, s23
    v_mfma_f32_16x16x32_bf16 v[108:111], a[232:235], v[152:155], v[108:111]
    s_add_u32 s100, s100, s4
    v_mfma_f32_16x16x32_bf16 v[108:111], a[236:239], v[156:159], v[108:111]
    s_lshl_b32 s100, s100, 10
    v_mfma_f32_16x16x32_bf16 v[112:115], a[240:243], v[144:147], v[112:115]
    ds_read_b128 v[136:139], v14 offset:1088
    v_mfma_f32_16x16x32_bf16 v[112:115], a[244:247], v[148:151], v[112:115]
    s_add_u32 s101, s17, 7
    v_mfma_f32_16x16x32_bf16 v[112:115], a[248:251], v[152:155], v[112:115]
    s_bfe_u32 s23, s101, 0x20001
    v_mfma_f32_16x16x32_bf16 v[112:115], a[252:255], v[156:159], v[112:115]
    s_mul_i32 s23, s23, 11
    v_mfma_f32_16x16x32_bf16 v[116:119], v[192:195], v[144:147], v[116:119]
    s_and_b32 s101, s101, 1
    v_mfma_f32_16x16x32_bf16 v[116:119], v[196:199], v[148:151], v[116:119]
    ds_read_b128 v[140:143], v14 offset:1024
    v_mfma_f32_16x16x32_bf16 v[116:119], v[200:203], v[152:155], v[116:119]
    s_lshl2_add_u32 s101, s101, s23
    v_mfma_f32_16x16x32_bf16 v[116:119], v[204:207], v[156:159], v[116:119]
    s_add_u32 s101, s101, s4
    v_mfma_f32_16x16x32_bf16 v[120:123], v[208:211], v[144:147], v[120:123]
    s_lshl_b32 s101, s101, 10
    v_mfma_f32_16x16x32_bf16 v[120:123], v[212:215], v[148:151], v[120:123]
    s_mul_i32 s20, s4, 11
    v_mfma_f32_16x16x32_bf16 v[120:123], v[216:219], v[152:155], v[120:123]
    ds_write_b128 v9, v[96:99] offset:0
    v_mfma_f32_16x16x32_bf16 v[120:123], v[220:223], v[156:159], v[120:123]
    s_add_u32 s20, s20, 8
    v_mfma_f32_16x16x32_bf16 v[124:127], v[224:227], v[144:147], v[124:127]
    s_lshl_b32 s20, s20, 10
    v_mfma_f32_16x16x32_bf16 v[124:127], v[228:231], v[148:151], v[124:127]
    s_add_u32 s21, s20, 1024
    v_mfma_f32_16x16x32_bf16 v[124:127], v[232:235], v[152:155], v[124:127]
    s_add_u32 s22, s20, 2048
    v_mfma_f32_16x16x32_bf16 v[124:127], v[236:239], v[156:159], v[124:127]
    s_lshl_b32 s27, s4, 11
    s_add_u32 s27, s27, 11730944
    buffer_load_dwordx2 v[72:73], v1, s[40:43], s27 offen sc1
    buffer_load_dwordx2 v[74:75], v1, s[40:43], s27 offen offset:1024 sc1
    s_waitcnt lgkmcnt(1)
    v_mfma_f32_16x16x32_bf16 v[104:107], a[192:195], v[128:131], v[104:107]
    v_mfma_f32_16x16x32_bf16 v[104:107], a[196:199], v[132:135], v[104:107]
    ds_read_b128 v[144:147], v14 offset:1728
    v_mfma_f32_16x16x32_bf16 v[104:107], a[200:203], v[136:139], v[104:107]
    ds_read_b128 v[148:151], v14 offset:1664
    v_mfma_f32_16x16x32_bf16 v[104:107], a[204:207], v[140:143], v[104:107]
    v_mfma_f32_16x16x32_bf16 v[108:111], a[208:211], v[128:131], v[108:111]
    ds_read_b128 v[152:155], v14 offset:1600
    v_mfma_f32_16x16x32_bf16 v[108:111], a[212:215], v[132:135], v[108:111]
    v_mfma_f32_16x16x32_bf16 v[108:111], a[216:219], v[136:139], v[108:111]
    ds_read_b128 v[156:159], v14 offset:1536
    v_mfma_f32_16x16x32_bf16 v[108:111], a[220:223], v[140:143], v[108:111]
    v_mfma_f32_16x16x32_bf16 v[112:115], a[224:227], v[128:131], v[112:115]
    ds_write_b128 v9, v[100:103] offset:1024
    v_mfma_f32_16x16x32_bf16 v[112:115], a[228:231], v[132:135], v[112:115]
    v_mfma_f32_16x16x32_bf16 v[112:115], a[232:235], v[136:139], v[112:115]
    s_waitcnt vmcnt(3)
    v_mfma_f32_16x16x32_bf16 v[112:115], a[236:239], v[140:143], v[112:115]
    v_mfma_f32_16x16x32_bf16 v[116:119], a[240:243], v[128:131], v[116:119]
    v_subrev_u32 v41, s25, v41
    v_mfma_f32_16x16x32_bf16 v[116:119], a[244:247], v[132:135], v[116:119]
    v_mfma_f32_16x16x32_bf16 v[116:119], a[248:251], v[136:139], v[116:119]
    v_cmp_ne_u64 vcc, s[36:37], v[40:41]
    s_nop 0
    s_cmp_eq_u64 vcc, 0
    s_cselect_b32 s26, 1, 0
    v_mfma_f32_16x16x32_bf16 v[116:119], a[252:255], v[140:143], v[116:119]
    v_mfma_f32_16x16x32_bf16 v[120:123], v[192:195], v[128:131], v[120:123]
    v_mfma_f32_16x16x32_bf16 v[68:71], v[32:35], v[32:35], 0
    v_mfma_f32_16x16x32_bf16 v[120:123], v[196:199], v[132:135], v[120:123]
    v_mfma_f32_16x16x32_bf16 v[120:123], v[200:203], v[136:139], v[120:123]
    v_mfma_f32_16x16x32_bf16 v[64:67], v[60:63], v[32:35], 0
    v_mfma_f32_16x16x32_bf16 v[120:123], v[204:207], v[140:143], v[120:123]
    v_mfma_f32_16x16x32_bf16 v[124:127], v[208:211], v[128:131], v[124:127]
    v_mfma_f32_16x16x32_bf16 v[68:71], v[36:39], v[36:39], v[68:71]
    v_mfma_f32_16x16x32_bf16 v[124:127], v[212:215], v[132:135], v[124:127]
    v_mfma_f32_16x16x32_bf16 v[124:127], v[216:219], v[136:139], v[124:127]
    v_mfma_f32_16x16x32_bf16 v[64:67], v[60:63], v[36:39], v[64:67]
    v_mfma_f32_16x16x32_bf16 v[124:127], v[220:223], v[140:143], v[124:127]
    s_mov_b32 s6, 100000
    s_waitcnt vmcnt(0)
    s_branch chk_interleave_layers__ssm_conv_h3__dense_activation_relu__prompt_kernel_8
polla_interleave_layers__ssm_conv_h3__dense_activation_relu__prompt_kernel_7:
    s_sleep 4
    s_lshl_b32 s27, s4, 11
    s_add_u32 s27, s27, 11730944
    buffer_load_dwordx2 v[72:73], v1, s[40:43], s27 offen sc1
    buffer_load_dwordx2 v[74:75], v1, s[40:43], s27 offen offset:1024 sc1
    s_waitcnt vmcnt(0)
chk_interleave_layers__ssm_conv_h3__dense_activation_relu__prompt_kernel_8:
    v_cmp_ne_u64 s[10:11], s[36:37], v[72:73]
    v_cmp_ne_u64 vcc, s[36:37], v[74:75]
    s_nop 0
    s_or_b64 vcc, vcc, s[10:11]
    s_cbranch_scc0 donea_interleave_layers__ssm_conv_h3__dense_activation_relu__prompt_kernel_9
    s_sub_u32 s6, s6, 1
    s_cmp_lg_u32 s6, 0
    s_cbranch_scc1 polla_interleave_layers__ssm_conv_h3__dense_activation_relu__prompt_kernel_7
donea_interleave_layers__ssm_conv_h3__dense_activation_relu__prompt_kernel_9:
    s_barrier
    s_waitcnt lgkmcnt(1)
    v_mfma_f32_16x16x32_bf16 v[108:111], a[192:195], v[144:147], v[108:111]
    v_mfma_f32_16x16x32_bf16 v[108:111], a[196:199], v[148:151], v[108:111]
    ds_read_b128 v[128:131], v14 offset:2240
    ds_read_b128 v[132:135], v14 offset:2176
    v_mfma_f32_16x16x32_bf16 v[108:111], a[200:203], v[152:155], v[108:111]
    ds_read_b128 v[136:139], v14 offset:2112
    ds_read_b128 v[140:143], v14 offset:2048
    v_mfma_f32_16x16x32_bf16 v[108:111], a[204:207], v[156:159], v[108:111]
    ds_write_b128 v9, v[104:107] offset:2048
    buffer_load_dwordx4 a[0:3], v18, s[40:43], s48 offen offset:0 sc1
    v_mfma_f32_16x16x32_bf16 v[112:115], a[208:211], v[144:147], v[112:115]
    buffer_load_dwordx4 a[4:7], v47, s[40:43], s48 offen offset:0 sc1
    buffer_load_dwordx4 a[8:11], v19, s[40:43], s48 offen offset:0 sc1
    v_mfma_f32_16x16x32_bf16 v[112:115], a[212:215], v[148:151], v[112:115]
    buffer_load_dwordx4 a[12:15], v18, s[40:43], s48 offen offset:1024 sc1
    buffer_load_dwordx4 a[16:19], v47, s[40:43], s48 offen offset:1024 sc1
    v_mfma_f32_16x16x32_bf16 v[112:115], a[216:219], v[152:155], v[112:115]
    buffer_load_dwordx4 a[20:23], v19, s[40:43], s48 offen offset:1024 sc1
    v_mfma_f32_16x16x32_bf16 v[112:115], a[220:223], v[156:159], v[112:115]
    buffer_load_dwordx4 a[24:27], v18, s[40:43], s49 offen offset:0 sc1
    buffer_load_dwordx4 a[28:31], v47, s[40:43], s49 offen offset:0 sc1
    v_mfma_f32_16x16x32_bf16 v[116:119], a[224:227], v[144:147], v[116:119]
    v_cndmask_b32 v65, v68, v69, s[60:61]
    v_cndmask_b32 v65, v65, v70, s[62:63]
    v_mfma_f32_16x16x32_bf16 v[116:119], a[228:231], v[148:151], v[116:119]
    v_cndmask_b32 v65, v65, v71, s[64:65]
    v_and_b32 v65, -2, v65
    v_mfma_f32_16x16x32_bf16 v[116:119], a[232:235], v[152:155], v[116:119]
    v_or_b32 v65, 0x80000000, v65
    s_cmp_eq_u32 s26, 0
    s_cbranch_scc1 L_g0s
    buffer_store_dwordx2 v[64:65], v6, s[40:43], 0 offen
    s_branch L_g0d
L_g0s:
    buffer_store_dwordx2 v[64:65], v6, s[40:43], 0 offen sc1
L_g0d:
    v_mfma_f32_16x16x32_bf16 v[116:119], a[236:239], v[156:159], v[116:119]
    buffer_load_dword v76, v6, s[40:43], 0 offen offset:512 sc1
    ds_write_b128 v9, v[108:111] offset:3072
    v_mfma_f32_16x16x32_bf16 v[120:123], a[240:243], v[144:147], v[120:123]
    v_mfma_f32_16x16x32_bf16 v[120:123], a[244:247], v[148:151], v[120:123]
    v_mfma_f32_16x16x32_bf16 v[120:123], a[248:251], v[152:155], v[120:123]
    v_mfma_f32_16x16x32_bf16 v[120:123], a[252:255], v[156:159], v[120:123]
    v_mfma_f32_16x16x32_bf16 v[124:127], v[192:195], v[144:147], v[124:127]
    v_mfma_f32_16x16x32_bf16 v[124:127], v[196:199], v[148:151], v[124:127]
    v_mfma_f32_16x16x32_bf16 v[124:127], v[200:203], v[152:155], v[124:127]
    v_mfma_f32_16x16x32_bf16 v[124:127], v[204:207], v[156:159], v[124:127]
    s_waitcnt lgkmcnt(0)
    s_barrier
    ds_read_b128 v[168:171], v10 offset:0
    ds_read_b128 v[172:175], v10 offset:8192
    ds_read_b128 v[176:179], v10 offset:2048
    ds_read_b128 v[180:183], v10 offset:10240
    v_mfma_f32_16x16x32_bf16 v[112:115], a[192:195], v[128:131], v[112:115]
    v_mfma_f32_16x16x32_bf16 v[112:115], a[196:199], v[132:135], v[112:115]
    ds_read_b128 v[144:147], v14 offset:2752
    ds_read_b128 v[148:151], v14 offset:2688
    v_mfma_f32_16x16x32_bf16 v[112:115], a[200:203], v[136:139], v[112:115]
    ds_read_b128 v[152:155], v14 offset:2624
    ds_read_b128 v[156:159], v14 offset:2560
    v_mfma_f32_16x16x32_bf16 v[112:115], a[204:207], v[140:143], v[112:115]
    v_and_b32 v184, s28, v161
    v_mfma_f32_16x16x32_bf16 v[116:119], a[208:211], v[128:131], v[116:119]
    buffer_load_dwordx4 a[32:35], v19, s[40:43], s49 offen offset:0 sc1
    v_lshlrev_b32 v185, 16, v161
    v_mfma_f32_16x16x32_bf16 v[116:119], a[212:215], v[132:135], v[116:119]
    v_and_b32 v186, s28, v160
    buffer_load_dwordx4 a[36:39], v18, s[40:43], s49 offen offset:1024 sc1
    v_mfma_f32_16x16x32_bf16 v[116:119], a[216:219], v[136:139], v[116:119]
    v_lshlrev_b32 v187, 16, v160
    v_mfma_f32_16x16x32_bf16 v[116:119], a[220:223], v[140:143], v[116:119]
    s_waitcnt lgkmcnt(6)
    v_fma_f32 v184, v184, s30, v168
    v_mfma_f32_16x16x32_bf16 v[120:123], a[224:227], v[128:131], v[120:123]
    buffer_load_dwordx4 a[40:43], v47, s[40:43], s49 offen offset:1024 sc1
    v_fma_f32 v185, v185, s30, v169
    v_mfma_f32_16x16x32_bf16 v[120:123], a[228:231], v[132:135], v[120:123]
    v_fma_f32 v186, v186, s30, v170
    v_mfma_f32_16x16x32_bf16 v[120:123], a[232:235], v[136:139], v[120:123]
    buffer_load_dwordx4 a[44:47], v19, s[40:43], s49 offen offset:1024 sc1
    v_fma_f32 v187, v187, s30, v171
    v_mfma_f32_16x16x32_bf16 v[120:123], a[236:239], v[140:143], v[120:123]
    v_add_f32 v184, v184, v172
    v_add_f32 v185, v185, v173
    v_mfma_f32_16x16x32_bf16 v[124:127], a[240:243], v[128:131], v[124:127]
    buffer_load_dwordx4 a[48:51], v18, s[40:43], s50 offen offset:0 sc1
    v_mfma_f32_16x16x32_bf16 v[124:127], a[244:247], v[132:135], v[124:127]
    v_add_f32 v186, v186, v174
    v_add_f32 v187, v187, v175
    v_mfma_f32_16x16x32_bf16 v[124:127], a[248:251], v[136:139], v[124:127]
    buffer_load_dwordx4 a[52:55], v47, s[40:43], s50 offen offset:0 sc1
    v_cvt_pk_bf16_f32 v188, v184, v185
    v_mfma_f32_16x16x32_bf16 v[124:127], a[252:255], v[140:143], v[124:127]
    v_cvt_pk_bf16_f32 v189, v186, v187
    s_waitcnt lgkmcnt(0)
    v_mfma_f32_16x16x32_bf16 v[116:119], a[192:195], v[144:147], v[116:119]
    v_mfma_f32_16x16x32_bf16 v[116:119], a[196:199], v[148:151], v[116:119]
    ds_read_b128 v[128:131], v14 offset:3264
    ds_read_b128 v[132:135], v14 offset:3200
    ds_read_b128 v[136:139], v14 offset:3136
    v_mfma_f32_16x16x32_bf16 v[116:119], a[200:203], v[152:155], v[116:119]
    ds_read_b128 v[140:143], v14 offset:3072
    ds_write_b128 v9, v[112:115] offset:4096
    v_and_b32 v184, s28, v163
    v_mfma_f32_16x16x32_bf16 v[116:119], a[204:207], v[156:159], v[116:119]
    buffer_load_dwordx4 a[56:59], v19, s[40:43], s50 offen offset:0 sc1
    v_lshlrev_b32 v185, 16, v163
    v_and_b32 v186, s28, v162
    v_mfma_f32_16x16x32_bf16 v[120:123], a[208:211], v[144:147], v[120:123]
    v_lshlrev_b32 v187, 16, v162
    buffer_load_dwordx4 a[60:63], v18, s[40:43], s50 offen offset:1024 sc1
    v_mfma_f32_16x16x32_bf16 v[120:123], a[212:215], v[148:151], v[120:123]
    v_fma_f32 v184, v184, s30, v176
    v_fma_f32 v185, v185, s30, v177
    v_mfma_f32_16x16x32_bf16 v[120:123], a[216:219], v[152:155], v[120:123]
    buffer_load_dwordx4 a[64:67], v47, s[40:43], s50 offen offset:1024 sc1
    v_fma_f32 v186, v186, s30, v178
    v_fma_f32 v187, v187, s30, v179
    v_mfma_f32_16x16x32_bf16 v[120:123], a[220:223], v[156:159], v[120:123]
    v_add_f32 v184, v184, v180
    buffer_load_dwordx4 a[68:71], v19, s[40:43], s50 offen offset:1024 sc1
    v_add_f32 v185, v185, v181
    v_mfma_f32_16x16x32_bf16 v[124:127], a[224:227], v[144:147], v[124:127]
    v_add_f32 v186, v186, v182
    v_add_f32 v187, v187, v183
    v_mfma_f32_16x16x32_bf16 v[124:127], a[228:231], v[148:151], v[124:127]
    buffer_load_dwordx4 a[72:75], v18, s[40:43], s51 offen offset:0 sc1
    v_cvt_pk_bf16_f32 v190, v184, v185
    v_cvt_pk_bf16_f32 v191, v186, v187
    v_mfma_f32_16x16x32_bf16 v[124:127], a[232:235], v[152:155], v[124:127]
    v_permlane16_swap_b32 v188, v190
    buffer_load_dwordx4 a[76:79], v47, s[40:43], s51 offen offset:0 sc1
    v_permlane16_swap_b32 v189, v191
    v_mfma_f32_16x16x32_bf16 v[124:127], a[236:239], v[156:159], v[124:127]
    s_mov_b32 s7, 0
    buffer_store_dwordx4 v[188:191], v8, s[44:47], s7 offen sc1
    s_waitcnt lgkmcnt(1)
    v_mfma_f32_16x16x32_bf16 v[120:123], a[192:195], v[128:131], v[120:123]
    v_mfma_f32_16x16x32_bf16 v[120:123], a[196:199], v[132:135], v[120:123]
    ds_read_b128 v[144:147], v14 offset:3776
    ds_read_b128 v[148:151], v14 offset:3712
    v_mfma_f32_16x16x32_bf16 v[120:123], a[200:203], v[136:139], v[120:123]
    ds_read_b128 v[152:155], v14 offset:3648
    v_mfma_f32_16x16x32_bf16 v[120:123], a[204:207], v[140:143], v[120:123]
    ds_read_b128 v[156:159], v14 offset:3584
    v_mfma_f32_16x16x32_bf16 v[124:127], a[208:211], v[128:131], v[124:127]
    ds_write_b128 v9, v[116:119] offset:5120
    buffer_load_dwordx4 a[80:83], v19, s[40:43], s51 offen offset:0 sc1
    v_mfma_f32_16x16x32_bf16 v[124:127], a[212:215], v[132:135], v[124:127]
    buffer_load_dwordx4 a[84:87], v18, s[40:43], s51 offen offset:1024 sc1
    v_mfma_f32_16x16x32_bf16 v[124:127], a[216:219], v[136:139], v[124:127]
    buffer_load_dwordx4 a[88:91], v47, s[40:43], s51 offen offset:1024 sc1
    v_mfma_f32_16x16x32_bf16 v[124:127], a[220:223], v[140:143], v[124:127]
    buffer_load_dwordx4 a[92:95], v19, s[40:43], s51 offen offset:1024 sc1
    s_waitcnt lgkmcnt(1)
    v_mfma_f32_16x16x32_bf16 v[124:127], a[192:195], v[144:147], v[124:127]
    v_mfma_f32_16x16x32_bf16 v[124:127], a[196:199], v[148:151], v[124:127]
    v_mfma_f32_16x16x32_bf16 v[124:127], a[200:203], v[152:155], v[124:127]
    v_mfma_f32_16x16x32_bf16 v[124:127], a[204:207], v[156:159], v[124:127]
    ds_write_b128 v9, v[120:123] offset:6144
    s_nop 6
    ds_write_b128 v9, v[124:127] offset:7168
    s_waitcnt lgkmcnt(0)
    s_barrier
    ds_read_b128 v[168:171], v10 offset:4096
    ds_read_b128 v[172:175], v10 offset:12288
    ds_read_b128 v[176:179], v10 offset:6144
    ds_read_b128 v[180:183], v10 offset:14336
    v_and_b32 v184, s28, v165
    v_lshlrev_b32 v185, 16, v165
    v_and_b32 v186, s28, v164
    v_lshlrev_b32 v187, 16, v164
    s_waitcnt lgkmcnt(2)
    v_fma_f32 v184, v184, s30, v168
    v_fma_f32 v185, v185, s30, v169
    v_fma_f32 v186, v186, s30, v170
    v_fma_f32 v187, v187, s30, v171
    v_add_f32 v184, v184, v172
    v_add_f32 v185, v185, v173
    v_add_f32 v186, v186, v174
    v_add_f32 v187, v187, v175
    v_cvt_pk_bf16_f32 v188, v184, v185
    v_cvt_pk_bf16_f32 v189, v186, v187
    v_and_b32 v184, s28, v167
    v_lshlrev_b32 v185, 16, v167
    v_and_b32 v186, s28, v166
    v_lshlrev_b32 v187, 16, v166
    s_waitcnt lgkmcnt(0)
    v_fma_f32 v184, v184, s30, v176
    v_fma_f32 v185, v185, s30, v177
    v_fma_f32 v186, v186, s30, v178
    v_fma_f32 v187, v187, s30, v179
    v_add_f32 v184, v184, v180
    v_add_f32 v185, v185, v181
    v_add_f32 v186, v186, v182
    v_add_f32 v187, v187, v183
    v_cvt_pk_bf16_f32 v190, v184, v185
    v_cvt_pk_bf16_f32 v191, v186, v187
    s_nop 0
    v_permlane16_swap_b32 v188, v190
    s_nop 0
    v_permlane16_swap_b32 v189, v191
    s_mov_b32 s7, 1048576
    buffer_store_dwordx4 v[188:191], v8, s[44:47], s7 offen sc1
    s_mov_b32 s27, 0x80000000
    s_branch L_t2
L_loop:
    v_mfma_f32_16x16x32_bf16 v[104:107], v[160:163], v[160:163], 0
    v_mfma_f32_16x16x32_bf16 v[100:103], v[20:23], v[160:163], 0
    v_mfma_f32_16x16x32_bf16 v[104:107], v[164:167], v[164:167], v[104:107]
    v_mfma_f32_16x16x32_bf16 v[100:103], v[20:23], v[164:167], v[100:103]
    s_nop 7
    v_cndmask_b32 v101, v104, v105, s[60:61]
    s_nop 6
    v_cndmask_b32 v101, v101, v106, s[62:63]
    s_nop 5
    v_cndmask_b32 v101, v101, v107, s[64:65]
    s_nop 4
    v_and_b32 v101, -2, v101
    s_nop 3
    v_or_b32 v101, s27, v101
    s_cmp_eq_u32 s26, 0
    s_cbranch_scc1 L_g1s
    s_nop 0
    buffer_store_dwordx2 v[100:101], v6, s[40:43], 0 offen
    s_branch L_g1d
L_g1s:
    s_nop 0
    buffer_store_dwordx2 v[100:101], v6, s[40:43], 0 offen sc1
L_g1d:
L_t2:
    s_mov_b32 s6, 100000
    s_mov_b32 s7, 0x80000001
L_gp:
    buffer_load_dwordx2 v[128:129], v11, s[40:43], 0 offen sc1
    buffer_load_dwordx2 v[130:131], v11, s[40:43], 0 offen offset:1024 sc1
    s_waitcnt vmcnt(0)
    v_and_b32 v132, s7, v129
    v_and_b32 v133, s7, v131
    v_cmp_ne_u32 s[10:11], s27, v132
    v_cmp_ne_u32 vcc, s27, v133
    s_nop 0
    s_or_b64 vcc, vcc, s[10:11]
    s_cbranch_scc0 L_gdone
    s_sub_u32 s6, s6, 1
    s_cmp_lg_u32 s6, 0
    s_cbranch_scc1 L_gp
L_gdone:
    v_add_f32 v132, v128, v130
    v_add_f32 v133, |v129|, |v131|
    v_mov_b32 v134, v132
    v_mov_b32 v135, v133
    s_nop 0
    v_permlane32_swap_b32 v132, v134
    s_nop 0
    v_permlane32_swap_b32 v133, v135
    v_add_f32 v132, v132, v134
    v_add_f32 v133, v133, v135
    v_mov_b32 v134, v132
    v_mov_b32 v135, v133
    s_nop 0
    v_permlane16_swap_b32 v132, v134
    s_nop 0
    v_permlane16_swap_b32 v133, v135
    v_add_f32 v132, v132, v134
    v_add_f32 v133, v133, v135
    v_mul_f32 v134, s29, v132
    v_mul_f32 v135, v134, v134
    v_fma_f32 v135, v133, s29, -v135
    v_max_f32 v135, 0, v135
    v_add_f32 v135, 0x3727c5ac, v135
    v_rsq_f32 v4, v135
    s_nop 0
    v_mul_f32 v5, -v134, v4
    s_bitcmp1_b32 s27, 0
    s_cbranch_scc1 L_havey
    s_add_u32 s6, s37, 32
    s_add_u32 s6, s6, s25
    v_mov_b32 v136, s36
    v_mov_b32 v137, s6
    s_barrier
    buffer_store_dwordx2 v[136:137], v29, s[40:43], 0 offen sc1
    s_mul_i32 s6, s16, 172
    buffer_load_dwordx4 a[96:99], v18, s[40:43], s52 offen offset:0 sc1
    s_add_u32 s7, s6, s56
    s_lshl_b32 s7, s7, 10
    v_add_u32 v8, s7, v1
    s_add_u32 s7, s6, s57
    buffer_load_dwordx4 a[100:103], v47, s[40:43], s52 offen offset:0 sc1
    s_lshl_b32 s7, s7, 10
    s_lshl_b32 s58, s58, 3
    s_add_u32 s7, s7, s58
    s_cmp_eq_u32 s59, 1
    buffer_load_dwordx4 a[104:107], v19, s[40:43], s52 offen offset:0 sc1
    s_cselect_b32 s7, s7, 2147418112
    v_add_u32 v9, s7, v1
    v_add_u32 v28, 384, v12
    v_and_b32 v42, 3, v2
    buffer_load_dwordx4 a[108:111], v18, s[40:43], s52 offen offset:1024 sc1
    v_bfe_u32 v43, v2, 2, 1
    v_lshl_add_u32 v43, v43, 4, v42
    s_lshl_b32 s6, s17, 5
    s_lshl_b32 s7, s4, 2
    buffer_load_dwordx4 a[112:115], v47, s[40:43], s52 offen offset:1024 sc1
    s_add_u32 s6, s6, s7
    v_add_u32 v43, s6, v43
    v_lshlrev_b32 v43, 7, v43
    v_add_u32 v16, 11993088, v43
    buffer_load_dwordx4 a[116:119], v19, s[40:43], s52 offen offset:1024 sc1
    v_lshrrev_b32 v43, 2, v2
    v_lshl_add_u32 v44, v3, 3, v43
    v_lshlrev_b32 v44, 7, v44
    v_lshl_add_u32 v44, v42, 3, v44
    buffer_load_dwordx4 a[120:123], v18, s[40:43], s53 offen offset:0 sc1
    v_lshrrev_b32 v43, 1, v43
    v_and_b32 v42, 1, v3
    v_lshl_or_b32 v43, v42, 1, v43
    v_xor_b32 v43, s4, v43
    buffer_load_dwordx4 a[124:127], v47, s[40:43], s53 offen offset:0 sc1
    v_lshl_add_u32 v10, v43, 5, v44
    v_add_u32 v10, 65536, v10
    s_lshl_b32 s6, s16, 13
    s_add_u32 s6, s6, 12059136
    buffer_load_dwordx4 a[128:131], v19, s[40:43], s53 offen offset:0 sc1
    v_lshrrev_b32 v12, 1, v1
    v_add_u32 v12, s6, v12
    s_movk_i32 s13, 4096
    s_lshl_b32 s6, s4, 6
    buffer_load_dwordx4 a[132:135], v18, s[40:43], s53 offen offset:1024 sc1
    v_lshl_add_u32 v27, v2, 2, s6
    v_and_b32 v42, 1, v2
    s_lshl_b32 s6, s4, 3
    s_add_u32 s6, s6, 384
    buffer_load_dwordx4 a[136:139], v47, s[40:43], s53 offen offset:1024 sc1
    v_lshl_add_u32 v0, v42, 2, s6
    s_lshl_b32 s31, s16, 16
    s_lshl_b32 s7, s4, 10
    s_add_u32 s31, s31, s7
    buffer_load_dwordx4 a[140:143], v19, s[40:43], s53 offen offset:1024 sc1
    s_lshl_b32 s6, s17, 13
    s_add_u32 s18, s31, s6
    s_add_u32 s19, s18, 4096
    s_mov_b32 s30, 0
    buffer_load_dwordx4 a[144:147], v18, s[40:43], s54 offen offset:0 sc1
    s_xor_b32 s6, s4, 0
    s_mul_i32 s56, s6, 12288
    s_add_u32 s56, s56, 16384
    s_lshl_b32 s7, s16, 2
    buffer_load_dwordx4 a[148:151], v47, s[40:43], s54 offen offset:0 sc1
    s_add_u32 s6, s6, s7
    s_mul_i32 s6, s6, 44032
    s_add_u32 s32, s6, 2097152
    s_xor_b32 s6, s4, 1
    buffer_load_dwordx4 a[152:155], v19, s[40:43], s54 offen offset:0 sc1
    s_mul_i32 s57, s6, 12288
    s_add_u32 s57, s57, 16384
    s_lshl_b32 s7, s16, 2
    s_add_u32 s6, s6, s7
    buffer_load_dwordx4 a[156:159], v18, s[40:43], s54 offen offset:1024 sc1
    s_mul_i32 s6, s6, 44032
    s_add_u32 s33, s6, 2097152
    s_xor_b32 s6, s4, 2
    s_mul_i32 s58, s6, 12288
    buffer_load_dwordx4 a[160:163], v47, s[40:43], s54 offen offset:1024 sc1
    s_add_u32 s58, s58, 16384
    s_lshl_b32 s7, s16, 2
    s_add_u32 s6, s6, s7
    s_mul_i32 s6, s6, 44032
    buffer_load_dwordx4 a[164:167], v19, s[40:43], s54 offen offset:1024 sc1
    s_add_u32 s34, s6, 2097152
    s_xor_b32 s6, s4, 3
    s_mul_i32 s59, s6, 12288
    s_add_u32 s59, s59, 16384
    buffer_load_dwordx4 a[168:171], v18, s[40:43], s55 offen offset:0 sc1
    s_lshl_b32 s7, s16, 2
    s_add_u32 s6, s6, s7
    s_mul_i32 s6, s6, 44032
    s_add_u32 s35, s6, 2097152
    buffer_load_dwordx4 a[172:175], v47, s[40:43], s55 offen offset:0 sc1
    v_mov_b32 v20, 0x3f803f80
    v_mov_b32 v21, 0x3f803f80
    v_mov_b32 v22, 0x3f803f80
    v_mov_b32 v23, 0x3f803f80
    buffer_load_dwordx4 a[176:179], v19, s[40:43], s55 offen offset:0 sc1
    v_lshlrev_b32 v240, 16, v32
    v_and_b32 v241, s28, v32
    v_lshlrev_b32 v242, 16, v33
    v_and_b32 v243, s28, v33
    buffer_load_dwordx4 a[180:183], v18, s[40:43], s55 offen offset:1024 sc1
    v_lshlrev_b32 v244, 16, v34
    v_and_b32 v245, s28, v34
    v_lshlrev_b32 v246, 16, v35
    v_and_b32 v247, s28, v35
    buffer_load_dwordx4 a[184:187], v47, s[40:43], s55 offen offset:1024 sc1
    v_lshlrev_b32 v248, 16, v36
    v_and_b32 v249, s28, v36
    v_lshlrev_b32 v250, 16, v37
    v_and_b32 v251, s28, v37
    buffer_load_dwordx4 a[188:191], v19, s[40:43], s55 offen offset:1024 sc1
    v_lshlrev_b32 v252, 16, v38
    v_and_b32 v253, s28, v38
    v_lshlrev_b32 v254, 16, v39
    v_and_b32 v255, s28, v39
    s_mov_b32 s6, 100000
    s_add_u32 s7, s37, 32
np_interleave_layers__ssm_conv_h3__dense_activation_relu__prompt_kernel_10:
    buffer_load_dwordx2 v[138:139], v16, s[40:43], 0 offen sc1
    s_waitcnt vmcnt(0)
    v_subrev_u32 v139, s7, v139
    v_cmp_ne_u32 s[10:11], s36, v138
    v_cmp_le_u32 vcc, 64, v139
    s_nop 0
    s_or_b64 vcc, vcc, s[10:11]
    s_cbranch_scc0 nd_interleave_layers__ssm_conv_h3__dense_activation_relu__prompt_kernel_11
    s_mov_b64 exec, vcc
    s_sleep 1
    s_sub_u32 s6, s6, 1
    s_cmp_lg_u32 s6, 0
    s_cbranch_scc1 np_interleave_layers__ssm_conv_h3__dense_activation_relu__prompt_kernel_10
nd_interleave_layers__ssm_conv_h3__dense_activation_relu__prompt_kernel_11:
    s_mov_b64 exec, -1
    s_lshl_b32 s7, s4, 10
    s_add_u32 m0, s7, 65536
    s_nop 0
    buffer_load_dwordx4 v1, s[44:47], s18 offen sc1 lds
    s_add_u32 m0, m0, 4096
    s_nop 0
    buffer_load_dwordx4 v1, s[44:47], s19 offen sc1 lds
    v_mfma_f32_16x16x32_bf16 v[112:115], a[0:3], v[20:23], 0
    s_add_u32 m0, s14, 0
    s_lshl2_add_u32 s9, s94, s5
    buffer_load_dwordx4 v1, s[40:43], s9 offen offset:0 sc1 lds
    v_mfma_f32_16x16x32_bf16 v[116:119], a[4:7], v[20:23], 0
    v_mfma_f32_16x16x32_bf16 v[120:123], a[8:11], v[20:23], 0
    v_mfma_f32_16x16x32_bf16 v[112:115], a[12:15], v[20:23], v[112:115]
    v_mfma_f32_16x16x32_bf16 v[116:119], a[16:19], v[20:23], v[116:119]
    s_add_u32 m0, s14, 0
    s_lshl2_add_u32 s9, s94, s5
    buffer_load_dwordx4 v1, s[40:43], s9 offen offset:1024 sc1 lds
    v_mfma_f32_16x16x32_bf16 v[120:123], a[20:23], v[20:23], v[120:123]
    v_mfma_f32_16x16x32_bf16 v[112:115], a[24:27], v[20:23], v[112:115]
    v_mfma_f32_16x16x32_bf16 v[116:119], a[28:31], v[20:23], v[116:119]
    v_mfma_f32_16x16x32_bf16 v[120:123], a[32:35], v[20:23], v[120:123]
    s_add_u32 m0, s14, 0
    s_lshl2_add_u32 s9, s94, s5
    buffer_load_dwordx4 v1, s[40:43], s9 offen offset:2048 sc1 lds
    v_mfma_f32_16x16x32_bf16 v[112:115], a[36:39], v[20:23], v[112:115]
    v_mfma_f32_16x16x32_bf16 v[116:119], a[40:43], v[20:23], v[116:119]
    v_mfma_f32_16x16x32_bf16 v[120:123], a[44:47], v[20:23], v[120:123]
    v_mfma_f32_16x16x32_bf16 v[112:115], a[48:51], v[20:23], v[112:115]
    s_add_u32 m0, s14, 0
    s_lshl2_add_u32 s9, s94, s5
    buffer_load_dwordx4 v1, s[40:43], s9 offen offset:3072 sc1 lds
    v_mfma_f32_16x16x32_bf16 v[116:119], a[52:55], v[20:23], v[116:119]
    v_mfma_f32_16x16x32_bf16 v[120:123], a[56:59], v[20:23], v[120:123]
    v_mfma_f32_16x16x32_bf16 v[112:115], a[60:63], v[20:23], v[112:115]
    v_mfma_f32_16x16x32_bf16 v[116:119], a[64:67], v[20:23], v[116:119]
    s_add_u32 m0, s14, 4096
    s_lshl2_add_u32 s9, s95, s5
    buffer_load_dwordx4 v1, s[40:43], s9 offen offset:0 sc1 lds
    v_mfma_f32_16x16x32_bf16 v[120:123], a[68:71], v[20:23], v[120:123]
    v_mfma_f32_16x16x32_bf16 v[112:115], a[72:75], v[20:23], v[112:115]
    v_mfma_f32_16x16x32_bf16 v[116:119], a[76:79], v[20:23], v[116:119]
    v_mfma_f32_16x16x32_bf16 v[120:123], a[80:83], v[20:23], v[120:123]
    s_add_u32 m0, s14, 4096
    s_lshl2_add_u32 s9, s95, s5
    buffer_load_dwordx4 v1, s[40:43], s9 offen offset:1024 sc1 lds
    v_mfma_f32_16x16x32_bf16 v[112:115], a[84:87], v[20:23], v[112:115]
    v_mfma_f32_16x16x32_bf16 v[116:119], a[88:91], v[20:23], v[116:119]
    v_mfma_f32_16x16x32_bf16 v[120:123], a[92:95], v[20:23], v[120:123]
    v_mfma_f32_16x16x32_bf16 v[112:115], a[96:99], v[20:23], v[112:115]
    s_add_u32 m0, s14, 4096
    s_lshl2_add_u32 s9, s95, s5
    buffer_load_dwordx4 v1, s[40:43], s9 offen offset:2048 sc1 lds
    v_mfma_f32_16x16x32_bf16 v[116:119], a[100:103], v[20:23], v[116:119]
    v_mfma_f32_16x16x32_bf16 v[120:123], a[104:107], v[20:23], v[120:123]
    v_mfma_f32_16x16x32_bf16 v[112:115], a[108:111], v[20:23], v[112:115]
    v_mfma_f32_16x16x32_bf16 v[116:119], a[112:115], v[20:23], v[116:119]
    s_add_u32 m0, s14, 4096
    s_lshl2_add_u32 s9, s95, s5
    buffer_load_dwordx4 v1, s[40:43], s9 offen offset:3072 sc1 lds
    v_mfma_f32_16x16x32_bf16 v[120:123], a[116:119], v[20:23], v[120:123]
    v_mfma_f32_16x16x32_bf16 v[112:115], a[120:123], v[20:23], v[112:115]
    v_mfma_f32_16x16x32_bf16 v[116:119], a[124:127], v[20:23], v[116:119]
    v_mfma_f32_16x16x32_bf16 v[120:123], a[128:131], v[20:23], v[120:123]
    s_add_u32 m0, s14, 8192
    s_lshl2_add_u32 s9, s96, s5
    buffer_load_dwordx4 v1, s[40:43], s9 offen offset:0 sc1 lds
    v_mfma_f32_16x16x32_bf16 v[112:115], a[132:135], v[20:23], v[112:115]
    v_mfma_f32_16x16x32_bf16 v[116:119], a[136:139], v[20:23], v[116:119]
    v_mfma_f32_16x16x32_bf16 v[120:123], a[140:143], v[20:23], v[120:123]
    v_mfma_f32_16x16x32_bf16 v[112:115], a[144:147], v[20:23], v[112:115]
    s_add_u32 m0, s14, 8192
    s_lshl2_add_u32 s9, s96, s5
    buffer_load_dwordx4 v1, s[40:43], s9 offen offset:1024 sc1 lds
    v_mfma_f32_16x16x32_bf16 v[116:119], a[148:151], v[20:23], v[116:119]
    v_mfma_f32_16x16x32_bf16 v[120:123], a[152:155], v[20:23], v[120:123]
    v_mfma_f32_16x16x32_bf16 v[112:115], a[156:159], v[20:23], v[112:115]
    v_mfma_f32_16x16x32_bf16 v[116:119], a[160:163], v[20:23], v[116:119]
    s_add_u32 m0, s14, 8192
    s_lshl2_add_u32 s9, s96, s5
    buffer_load_dwordx4 v1, s[40:43], s9 offen offset:2048 sc1 lds
    v_mfma_f32_16x16x32_bf16 v[120:123], a[164:167], v[20:23], v[120:123]
    v_mfma_f32_16x16x32_bf16 v[112:115], a[168:171], v[20:23], v[112:115]
    v_mfma_f32_16x16x32_bf16 v[116:119], a[172:175], v[20:23], v[116:119]
    v_mfma_f32_16x16x32_bf16 v[120:123], a[176:179], v[20:23], v[120:123]
    s_add_u32 m0, s14, 8192
    s_lshl2_add_u32 s9, s96, s5
    buffer_load_dwordx4 v1, s[40:43], s9 offen offset:3072 sc1 lds
    v_mfma_f32_16x16x32_bf16 v[112:115], a[180:183], v[20:23], v[112:115]
    v_mfma_f32_16x16x32_bf16 v[116:119], a[184:187], v[20:23], v[116:119]
    v_mfma_f32_16x16x32_bf16 v[120:123], a[188:191], v[20:23], v[120:123]
    s_lshl_b32 s6, s4, 10
    v_add_u32 v18, s6, v1
    v_add_u32 v24, s31, v1
    v_xor_b32 v19, 1024, v18
    v_xor_b32 v13, 2048, v18
    v_xor_b32 v17, 3072, v18
    s_xor_b32 s6, s4, 0
    s_mul_i32 s6, s6, 44032
    s_add_u32 s48, s6, 2097152
    s_xor_b32 s6, s4, 1
    s_mul_i32 s6, s6, 44032
    s_add_u32 s49, s6, 2097152
    s_xor_b32 s6, s4, 2
    s_mul_i32 s6, s6, 44032
    s_add_u32 s50, s6, 2097152
    s_xor_b32 s6, s4, 3
    s_mul_i32 s6, s6, 44032
    s_add_u32 s51, s6, 2097152
    s_waitcnt vmcnt(12)
    s_barrier
    ds_read_b64_tr_b16 v[100:101], v10 offset:0
    ds_read_b64_tr_b16 v[102:103], v10 offset:512
    ds_read_b64_tr_b16 v[104:105], v10 offset:4096
    ds_read_b64_tr_b16 v[106:107], v10 offset:4608
    s_waitcnt lgkmcnt(0)
    v_lshlrev_b32 v176, 16, v100
    v_and_b32 v177, s28, v100
    v_lshlrev_b32 v178, 16, v101
    v_and_b32 v179, s28, v101
    v_lshlrev_b32 v180, 16, v102
    v_and_b32 v181, s28, v102
    v_lshlrev_b32 v182, 16, v103
    v_and_b32 v183, s28, v103
    v_lshlrev_b32 v184, 16, v104
    v_and_b32 v185, s28, v104
    v_lshlrev_b32 v186, 16, v105
    v_and_b32 v187, s28, v105
    v_lshlrev_b32 v188, 16, v106
    v_and_b32 v189, s28, v106
    v_lshlrev_b32 v190, 16, v107
    v_and_b32 v191, s28, v107
L_havey:
    v_pk_fma_f32 v[128:129], v[240:241], v[4:5], v[4:5] op_sel:[0,0,1] op_sel_hi:[1,0,1]
    v_pk_fma_f32 v[128:129], v[128:129], v[176:177], v[240:241]
    v_cvt_pk_bf16_f32 v108, v128, v129
    v_pk_fma_f32 v[130:131], v[242:243], v[4:5], v[4:5] op_sel:[0,0,1] op_sel_hi:[1,0,1]
    v_pk_fma_f32 v[130:131], v[130:131], v[178:179], v[242:243]
    v_cvt_pk_bf16_f32 v109, v130, v131
    v_pk_fma_f32 v[128:129], v[244:245], v[4:5], v[4:5] op_sel:[0,0,1] op_sel_hi:[1,0,1]
    v_pk_fma_f32 v[128:129], v[128:129], v[180:181], v[244:245]
    v_cvt_pk_bf16_f32 v110, v128, v129
    v_pk_fma_f32 v[130:131], v[246:247], v[4:5], v[4:5] op_sel:[0,0,1] op_sel_hi:[1,0,1]
    v_pk_fma_f32 v[130:131], v[130:131], v[182:183], v[246:247]
    v_cvt_pk_bf16_f32 v111, v130, v131
    buffer_store_dwordx4 v[108:111], v1, s[44:47], s18 offen
    v_pk_fma_f32 v[128:129], v[248:249], v[4:5], v[4:5] op_sel:[0,0,1] op_sel_hi:[1,0,1]
    v_pk_fma_f32 v[128:129], v[128:129], v[184:185], v[248:249]
    v_cvt_pk_bf16_f32 v124, v128, v129
    v_pk_fma_f32 v[130:131], v[250:251], v[4:5], v[4:5] op_sel:[0,0,1] op_sel_hi:[1,0,1]
    v_pk_fma_f32 v[130:131], v[130:131], v[186:187], v[250:251]
    v_cvt_pk_bf16_f32 v125, v130, v131
    v_pk_fma_f32 v[128:129], v[252:253], v[4:5], v[4:5] op_sel:[0,0,1] op_sel_hi:[1,0,1]
    v_pk_fma_f32 v[128:129], v[128:129], v[188:189], v[252:253]
    v_cvt_pk_bf16_f32 v126, v128, v129
    v_pk_fma_f32 v[130:131], v[254:255], v[4:5], v[4:5] op_sel:[0,0,1] op_sel_hi:[1,0,1]
    v_pk_fma_f32 v[130:131], v[130:131], v[190:191], v[254:255]
    v_cvt_pk_bf16_f32 v127, v130, v131
    buffer_store_dwordx4 v[124:127], v1, s[44:47], s19 offen
    ds_write_b128 v18, v[108:111]
    ds_write_b128 v18, v[124:127] offset:4096
    v_mfma_f32_16x16x32_bf16 v[104:107], v[108:111], v[108:111], 0
    v_mfma_f32_16x16x32_bf16 v[100:103], v[20:23], v[108:111], 0
    v_mfma_f32_16x16x32_bf16 v[104:107], v[124:127], v[124:127], v[104:107]
    v_mfma_f32_16x16x32_bf16 v[100:103], v[20:23], v[124:127], v[100:103]
    s_nop 7
    v_cndmask_b32 v101, v104, v105, s[60:61]
    s_nop 6
    v_cndmask_b32 v101, v101, v106, s[62:63]
    s_nop 5
    v_cndmask_b32 v101, v101, v107, s[64:65]
    s_nop 4
    v_and_b32 v101, -2, v101
    s_nop 3
    v_or_b32 v101, s27, v101
    s_cmp_eq_u32 s26, 0
    s_cbranch_scc1 L_p3s
    s_nop 0
    buffer_store_dwordx2 v[100:101], v6, s[40:43], 0 offen offset:512
    s_branch L_p3d
L_p3s:
    s_nop 0
    buffer_store_dwordx2 v[100:101], v6, s[40:43], 0 offen offset:512 sc1
L_p3d:
    s_lshl_b32 s24, s17, 13
    s_add_u32 s24, s24, 4096
    s_lshl_b32 s7, s4, 10
    s_add_u32 m0, s7, 4096
    s_waitcnt vmcnt(1) lgkmcnt(0)
    s_add_u32 s30, s30, 1
    v_mov_b32 v188, s30
    s_barrier
    s_cmp_eq_u32 s26, 0
    s_cbranch_scc1 slow_interleave_layers__ssm_conv_h3__dense_activation_relu__prompt_kernel_12
    buffer_store_dword v188, v7, s[40:43], 0 offen offset:384
    s_branch pub_interleave_layers__ssm_conv_h3__dense_activation_relu__prompt_kernel_13
slow_interleave_layers__ssm_conv_h3__dense_activation_relu__prompt_kernel_12:
    s_waitcnt vmcnt(0)
    s_cmp_lg_u32 s4, 0
    s_cbranch_scc1 pub_interleave_layers__ssm_conv_h3__dense_activation_relu__prompt_kernel_13
    buffer_wbl2 sc1
    s_waitcnt vmcnt(0)
    buffer_store_dword v188, v7, s[40:43], 0 offen offset:384 sc1
pub_interleave_layers__ssm_conv_h3__dense_activation_relu__prompt_kernel_13:
    ds_read_b128 v[32:35], v18 offset:0
    ds_read_b128 v[36:39], v19 offset:0
    ds_read_b128 v[40:43], v13 offset:0
    ds_read_b128 v[44:47], v17 offset:0
    ds_read_b128 v[48:51], v18 offset:4096
    ds_read_b128 v[52:55], v19 offset:4096
    ds_read_b128 v[56:59], v13 offset:4096
    ds_read_b128 v[60:63], v17 offset:4096
    s_waitcnt lgkmcnt(7)
    v_mfma_f32_16x16x32_bf16 v[128:131], a[0:3], v[32:35], 0
    v_mfma_f32_16x16x32_bf16 v[132:135], a[4:7], v[32:35], 0
    v_mfma_f32_16x16x32_bf16 v[160:163], a[8:11], v[32:35], 0
    s_waitcnt lgkmcnt(6)
    v_mfma_f32_16x16x32_bf16 v[136:139], a[0:3], v[36:39], 0
    v_mfma_f32_16x16x32_bf16 v[140:143], a[4:7], v[36:39], 0
    v_mfma_f32_16x16x32_bf16 v[164:167], a[8:11], v[36:39], 0
    s_waitcnt lgkmcnt(5)
    v_mfma_f32_16x16x32_bf16 v[144:147], a[0:3], v[40:43], 0
    v_mfma_f32_16x16x32_bf16 v[148:151], a[4:7], v[40:43], 0
    v_mfma_f32_16x16x32_bf16 v[168:171], a[8:11], v[40:43], 0
    s_waitcnt lgkmcnt(4)
    v_mfma_f32_16x16x32_bf16 v[152:155], a[0:3], v[44:47], 0
    v_mfma_f32_16x16x32_bf16 v[156:159], a[4:7], v[44:47], 0
    v_mfma_f32_16x16x32_bf16 v[172:175], a[8:11], v[44:47], 0
    s_waitcnt lgkmcnt(3)
    v_mfma_f32_16x16x32_bf16 v[128:131], a[12:15], v[48:51], v[128:131]
    v_mfma_f32_16x16x32_bf16 v[132:135], a[16:19], v[48:51], v[132:135]
    buffer_load_dword v189, v28, s[40:43], s12 offen sc1
    v_mfma_f32_16x16x32_bf16 v[160:163], a[20:23], v[48:51], v[160:163]
    s_waitcnt lgkmcnt(2)
    v_mfma_f32_16x16x32_bf16 v[136:139], a[12:15], v[52:55], v[136:139]
    v_mfma_f32_16x16x32_bf16 v[140:143], a[16:19], v[52:55], v[140:143]
    v_mfma_f32_16x16x32_bf16 v[164:167], a[20:23], v[52:55], v[164:167]
    s_waitcnt lgkmcnt(1)
    v_mfma_f32_16x16x32_bf16 v[144:147], a[12:15], v[56:59], v[144:147]
    v_mfma_f32_16x16x32_bf16 v[148:151], a[16:19], v[56:59], v[148:151]
    v_mfma_f32_16x16x32_bf16 v[168:171], a[20:23], v[56:59], v[168:171]
    s_waitcnt lgkmcnt(0)
    v_mfma_f32_16x16x32_bf16 v[152:155], a[12:15], v[60:63], v[152:155]
    v_mfma_f32_16x16x32_bf16 v[156:159], a[16:19], v[60:63], v[156:159]
    v_mfma_f32_16x16x32_bf16 v[172:175], a[20:23], v[60:63], v[172:175]
    s_waitcnt vmcnt(0)
    v_cmp_gt_u32 vcc, s30, v189
    s_cbranch_vccz L_xok
    s_mov_b32 s6, 100000
poll_interleave_layers__ssm_conv_h3__dense_activation_relu__prompt_kernel_14:
    buffer_load_dword v189, v28, s[40:43], s12 offen sc1
    s_waitcnt vmcnt(0)
    v_cmp_gt_u32 vcc, s30, v189
    s_cbranch_vccz done_interleave_layers__ssm_conv_h3__dense_activation_relu__prompt_kernel_15
    s_sub_u32 s6, s6, 1
    s_cmp_lg_u32 s6, 0
    s_cbranch_scc1 poll_interleave_layers__ssm_conv_h3__dense_activation_relu__prompt_kernel_14
done_interleave_layers__ssm_conv_h3__dense_activation_relu__prompt_kernel_15:
L_xok:
    s_cmp_lg_u32 s26, 0
    s_cbranch_scc1 acq_interleave_layers__ssm_conv_h3__dense_activation_relu__prompt_kernel_16
    buffer_inv sc1
    s_waitcnt vmcnt(0)
acq_interleave_layers__ssm_conv_h3__dense_activation_relu__prompt_kernel_16:
    s_add_u32 m0, m0, 4096
    s_add_u32 s24, s24, 4096
    s_and_b32 s24, s24, 0xffff
    buffer_load_dwordx4 v24, s[44:47], s24 offen sc1 lds
    s_add_u32 m0, m0, 4096
    s_add_u32 s24, s24, 4096
    s_and_b32 s24, s24, 0xffff
    buffer_load_dwordx4 v24, s[44:47], s24 offen sc1 lds
    s_add_u32 m0, m0, 4096
    s_add_u32 s24, s24, 4096
    s_and_b32 s24, s24, 0xffff
    buffer_load_dwordx4 v24, s[44:47], s24 offen sc1 lds
    s_add_u32 m0, m0, 4096
    s_add_u32 s24, s24, 4096
    s_and_b32 s24, s24, 0xffff
    buffer_load_dwordx4 v24, s[44:47], s24 offen sc1 lds
    s_add_u32 m0, m0, 4096
    s_add_u32 s24, s24, 4096
    s_and_b32 s24, s24, 0xffff
    buffer_load_dwordx4 v24, s[44:47], s24 offen sc1 lds
    s_add_u32 m0, m0, 4096
    s_add_u32 s24, s24, 4096
    s_and_b32 s24, s24, 0xffff
    buffer_load_dwordx4 v24, s[44:47], s24 offen sc1 lds
    s_add_u32 m0, m0, 4096
    s_add_u32 s24, s24, 4096
    s_and_b32 s24, s24, 0xffff
    buffer_load_dwordx4 v24, s[44:47], s24 offen sc1 lds
    s_add_u32 m0, m0, 4096
    s_add_u32 s24, s24, 4096
    s_and_b32 s24, s24, 0xffff
    buffer_load_dwordx4 v24, s[44:47], s24 offen sc1 lds
    s_waitcnt vmcnt(4)
    s_barrier
    ds_read_b128 v[64:67], v18 offset:8192
    ds_read_b128 v[68:71], v19 offset:8192
    ds_read_b128 v[72:75], v13 offset:8192
    ds_read_b128 v[76:79], v17 offset:8192
    ds_read_b128 v[32:35], v18 offset:12288
    ds_read_b128 v[36:39], v19 offset:12288
    s_bitcmp1_b32 s27, 0
    s_cbranch_scc1 L_g1b
    s_waitcnt lgkmcnt(5)
    v_mfma_f32_16x16x32_bf16 v[128:131], a[24:27], v[64:67], v[128:131]
    ds_read_b128 v[40:43], v13 offset:12288
    s_add_u32 m0, m0, 4096
    s_add_u32 s24, s24, 4096
    s_and_b32 s24, s24, 0xffff
    buffer_load_dwordx4 v24, s[44:47], s24 offen sc1 lds
    v_mfma_f32_16x16x32_bf16 v[132:135], a[28:31], v[64:67], v[132:135]
    v_mfma_f32_16x16x32_bf16 v[160:163], a[32:35], v[64:67], v[160:163]
    s_waitcnt lgkmcnt(5)
    v_mfma_f32_16x16x32_bf16 v[136:139], a[24:27], v[68:71], v[136:139]
    ds_read_b128 v[44:47], v17 offset:12288
    v_mfma_f32_16x16x32_bf16 v[140:143], a[28:31], v[68:71], v[140:143]
    s_add_u32 m0, m0, 4096
    s_add_u32 s24, s24, 4096
    s_and_b32 s24, s24, 0xffff
    buffer_load_dwordx4 v24, s[44:47], s24 offen sc1 lds
    v_mfma_f32_16x16x32_bf16 v[164:167], a[32:35], v[68:71], v[164:167]
    s_waitcnt lgkmcnt(5)
    v_mfma_f32_16x16x32_bf16 v[144:147], a[24:27], v[72:75], v[144:147]
    ds_read_b128 v[48:51], v18 offset:16384
    v_mfma_f32_16x16x32_bf16 v[148:151], a[28:31], v[72:75], v[148:151]
    v_mfma_f32_16x16x32_bf16 v[168:171], a[32:35], v[72:75], v[168:171]
    s_add_u32 m0, m0, 4096
    s_add_u32 s24, s24, 4096
    s_and_b32 s24, s24, 0xffff
    buffer_load_dwordx4 v24, s[44:47], s24 offen sc1 lds
    s_waitcnt lgkmcnt(5)
    v_mfma_f32_16x16x32_bf16 v[152:155], a[24:27], v[76:79], v[152:155]
    ds_read_b128 v[52:55], v19 offset:16384
    v_mfma_f32_16x16x32_bf16 v[156:159], a[28:31], v[76:79], v[156:159]
    v_mfma_f32_16x16x32_bf16 v[172:175], a[32:35], v[76:79], v[172:175]
    s_waitcnt lgkmcnt(5)
    v_mfma_f32_16x16x32_bf16 v[128:131], a[36:39], v[32:35], v[128:131]
    ds_read_b128 v[56:59], v13 offset:16384
    s_add_u32 m0, m0, 4096
    s_add_u32 s24, s24, 4096
    s_and_b32 s24, s24, 0xffff
    buffer_load_dwordx4 v24, s[44:47], s24 offen sc1 lds
    v_mfma_f32_16x16x32_bf16 v[132:135], a[40:43], v[32:35], v[132:135]
    v_mfma_f32_16x16x32_bf16 v[160:163], a[44:47], v[32:35], v[160:163]
    s_waitcnt lgkmcnt(5)
    v_mfma_f32_16x16x32_bf16 v[136:139], a[36:39], v[36:39], v[136:139]
    ds_read_b128 v[60:63], v17 offset:16384
    v_mfma_f32_16x16x32_bf16 v[140:143], a[40:43], v[36:39], v[140:143]
    s_add_u32 m0, m0, 4096
    s_add_u32 s24, s24, 4096
    s_and_b32 s24, s24, 0xffff
    buffer_load_dwordx4 v24, s[44:47], s24 offen sc1 lds
    v_mfma_f32_16x16x32_bf16 v[164:167], a[44:47], v[36:39], v[164:167]
    s_waitcnt lgkmcnt(5)
    v_mfma_f32_16x16x32_bf16 v[144:147], a[36:39], v[40:43], v[144:147]
    ds_read_b128 v[64:67], v18 offset:20480
    v_mfma_f32_16x16x32_bf16 v[148:151], a[40:43], v[40:43], v[148:151]
    v_mfma_f32_16x16x32_bf16 v[168:171], a[44:47], v[40:43], v[168:171]
    s_add_u32 m0, m0, 4096
    s_add_u32 s24, s24, 4096
    s_and_b32 s24, s24, 0xffff
    buffer_load_dwordx4 v24, s[44:47], s24 offen sc1 lds
    s_waitcnt lgkmcnt(5)
    v_mfma_f32_16x16x32_bf16 v[152:155], a[36:39], v[44:47], v[152:155]
    ds_read_b128 v[68:71], v19 offset:20480
    v_mfma_f32_16x16x32_bf16 v[156:159], a[40:43], v[44:47], v[156:159]
    v_mfma_f32_16x16x32_bf16 v[172:175], a[44:47], v[44:47], v[172:175]
    s_waitcnt vmcnt(6)
    s_barrier
    s_waitcnt lgkmcnt(5)
    v_mfma_f32_16x16x32_bf16 v[128:131], a[48:51], v[48:51], v[128:131]
    ds_read_b128 v[72:75], v13 offset:20480
    buffer_load_dwordx2 v[80:81], v12, s[40:43], 0 offen offset:0 sc1
    buffer_load_dwordx2 v[82:83], v12, s[40:43], 0 offen offset:1024 sc1
    v_mfma_f32_16x16x32_bf16 v[132:135], a[52:55], v[48:51], v[132:135]
    v_mfma_f32_16x16x32_bf16 v[160:163], a[56:59], v[48:51], v[160:163]
    s_waitcnt lgkmcnt(5)
    v_mfma_f32_16x16x32_bf16 v[136:139], a[48:51], v[52:55], v[136:139]
    ds_read_b128 v[76:79], v17 offset:20480
    v_mfma_f32_16x16x32_bf16 v[140:143], a[52:55], v[52:55], v[140:143]
    buffer_load_dwordx2 v[84:85], v12, s[40:43], 0 offen offset:2048 sc1
    buffer_load_dwordx2 v[86:87], v12, s[40:43], 0 offen offset:3072 sc1
    v_mfma_f32_16x16x32_bf16 v[164:167], a[56:59], v[52:55], v[164:167]
    s_waitcnt lgkmcnt(5)
    v_mfma_f32_16x16x32_bf16 v[144:147], a[48:51], v[56:59], v[144:147]
    ds_read_b128 v[32:35], v18 offset:24576
    v_mfma_f32_16x16x32_bf16 v[148:151], a[52:55], v[56:59], v[148:151]
    v_mfma_f32_16x16x32_bf16 v[168:171], a[56:59], v[56:59], v[168:171]
    buffer_load_dwordx2 v[88:89], v12, s[40:43], s13 offen offset:0 sc1
    buffer_load_dwordx2 v[90:91], v12, s[40:43], s13 offen offset:1024 sc1
    s_waitcnt lgkmcnt(5)
    v_mfma_f32_16x16x32_bf16 v[152:155], a[48:51], v[60:63], v[152:155]
    ds_read_b128 v[36:39], v19 offset:24576
    v_mfma_f32_16x16x32_bf16 v[156:159], a[52:55], v[60:63], v[156:159]
    v_mfma_f32_16x16x32_bf16 v[172:175], a[56:59], v[60:63], v[172:175]
    s_waitcnt lgkmcnt(5)
    v_mfma_f32_16x16x32_bf16 v[128:131], a[60:63], v[64:67], v[128:131]
    ds_read_b128 v[40:43], v13 offset:24576
    buffer_load_dwordx2 v[92:93], v12, s[40:43], s13 offen offset:2048 sc1
    buffer_load_dwordx2 v[94:95], v12, s[40:43], s13 offen offset:3072 sc1
    v_mfma_f32_16x16x32_bf16 v[132:135], a[64:67], v[64:67], v[132:135]
    v_mfma_f32_16x16x32_bf16 v[160:163], a[68:71], v[64:67], v[160:163]
    s_waitcnt lgkmcnt(5)
    v_mfma_f32_16x16x32_bf16 v[136:139], a[60:63], v[68:71], v[136:139]
    ds_read_b128 v[44:47], v17 offset:24576
    v_mfma_f32_16x16x32_bf16 v[140:143], a[64:67], v[68:71], v[140:143]
    s_add_u32 m0, s14, 12288
    s_lshl2_add_u32 s9, s97, s5
    buffer_load_dwordx4 v1, s[40:43], s9 offen offset:0 sc1 lds
    v_mfma_f32_16x16x32_bf16 v[164:167], a[68:71], v[68:71], v[164:167]
    s_waitcnt lgkmcnt(5)
    v_mfma_f32_16x16x32_bf16 v[144:147], a[60:63], v[72:75], v[144:147]
    ds_read_b128 v[48:51], v18 offset:28672
    v_mfma_f32_16x16x32_bf16 v[148:151], a[64:67], v[72:75], v[148:151]
    v_mfma_f32_16x16x32_bf16 v[168:171], a[68:71], v[72:75], v[168:171]
    s_add_u32 m0, s14, 12288
    s_lshl2_add_u32 s9, s97, s5
    buffer_load_dwordx4 v1, s[40:43], s9 offen offset:1024 sc1 lds
    s_waitcnt lgkmcnt(5)
    v_mfma_f32_16x16x32_bf16 v[152:155], a[60:63], v[76:79], v[152:155]
    ds_read_b128 v[52:55], v19 offset:28672
    v_mfma_f32_16x16x32_bf16 v[156:159], a[64:67], v[76:79], v[156:159]
    v_mfma_f32_16x16x32_bf16 v[172:175], a[68:71], v[76:79], v[172:175]
    s_waitcnt lgkmcnt(5)
    v_mfma_f32_16x16x32_bf16 v[128:131], a[72:75], v[32:35], v[128:131]
    ds_read_b128 v[56:59], v13 offset:28672
    s_add_u32 m0, s14, 12288
    s_lshl2_add_u32 s9, s97, s5
    buffer_load_dwordx4 v1, s[40:43], s9 offen offset:2048 sc1 lds
    v_mfma_f32_16x16x32_bf16 v[132:135], a[76:79], v[32:35], v[132:135]
    s_waitcnt lgkmcnt(5)
    v_mfma_f32_16x16x32_bf16 v[136:139], a[72:75], v[36:39], v[136:139]
    ds_read_b128 v[60:63], v17 offset:28672
    s_add_u32 m0, s14, 12288
    s_lshl2_add_u32 s9, s97, s5
    buffer_load_dwordx4 v1, s[40:43], s9 offen offset:3072 sc1 lds
    v_mfma_f32_16x16x32_bf16 v[140:143], a[76:79], v[36:39], v[140:143]
    s_waitcnt lgkmcnt(5)
    v_mfma_f32_16x16x32_bf16 v[144:147], a[72:75], v[40:43], v[144:147]
    ds_read_b128 v[64:67], v18 offset:32768
    v_mfma_f32_16x16x32_bf16 v[148:151], a[76:79], v[40:43], v[148:151]
    s_lshl2_add_u32 s15, s98, s5
    buffer_load_dwordx4 a[192:195], v1, s[40:43], s15 offen offset:0 sc1
    s_waitcnt lgkmcnt(5)
    v_mfma_f32_16x16x32_bf16 v[152:155], a[72:75], v[44:47], v[152:155]
    ds_read_b128 v[68:71], v19 offset:32768
    v_mfma_f32_16x16x32_bf16 v[156:159], a[76:79], v[44:47], v[156:159]
    s_waitcnt lgkmcnt(5)
    v_mfma_f32_16x16x32_bf16 v[128:131], a[84:87], v[48:51], v[128:131]
    ds_read_b128 v[72:75], v13 offset:32768
    s_lshl2_add_u32 s15, s98, s5
    buffer_load_dwordx4 a[196:199], v1, s[40:43], s15 offen offset:1024 sc1
    v_mfma_f32_16x16x32_bf16 v[132:135], a[88:91], v[48:51], v[132:135]
    s_waitcnt lgkmcnt(5)
    v_mfma_f32_16x16x32_bf16 v[136:139], a[84:87], v[52:55], v[136:139]
    ds_read_b128 v[76:79], v17 offset:32768
    s_lshl2_add_u32 s15, s98, s5
    buffer_load_dwordx4 a[200:203], v1, s[40:43], s15 offen offset:2048 sc1
    v_mfma_f32_16x16x32_bf16 v[140:143], a[88:91], v[52:55], v[140:143]
    s_waitcnt lgkmcnt(5)
    v_mfma_f32_16x16x32_bf16 v[144:147], a[84:87], v[56:59], v[144:147]
    ds_read_b128 v[32:35], v18 offset:36864
    v_mfma_f32_16x16x32_bf16 v[148:151], a[88:91], v[56:59], v[148:151]
    s_lshl2_add_u32 s15, s98, s5
    buffer_load_dwordx4 a[204:207], v1, s[40:43], s15 offen offset:3072 sc1
    s_waitcnt lgkmcnt(5)
    v_mfma_f32_16x16x32_bf16 v[152:155], a[84:87], v[60:63], v[152:155]
    ds_read_b128 v[36:39], v19 offset:36864
    v_mfma_f32_16x16x32_bf16 v[156:159], a[88:91], v[60:63], v[156:159]
    s_waitcnt vmcnt(16)
    s_barrier
    s_waitcnt lgkmcnt(5)
    v_mfma_f32_16x16x32_bf16 v[128:131], a[96:99], v[64:67], v[128:131]
    ds_read_b128 v[40:43], v13 offset:36864
    s_waitcnt vmcnt(8)
    s_lshl2_add_u32 s15, s99, s5
    buffer_load_dwordx4 a[208:211], v1, s[40:43], s15 offen offset:0 sc1
    v_mfma_f32_16x16x32_bf16 v[132:135], a[100:103], v[64:67], v[132:135]
    v_and_b32 v96, v81, v83
    v_or_b32 v97, v81, v83
    s_waitcnt lgkmcnt(5)
    v_mfma_f32_16x16x32_bf16 v[136:139], a[96:99], v[68:71], v[136:139]
    ds_read_b128 v[44:47], v17 offset:36864
    v_and_b32 v98, v85, v87
    v_or3_b32 v97, v97, v85, v87
    v_mfma_f32_16x16x32_bf16 v[140:143], a[100:103], v[68:71], v[140:143]
    s_lshl2_add_u32 s15, s99, s5
    buffer_load_dwordx4 a[212:215], v1, s[40:43], s15 offen offset:1024 sc1
    v_and_b32 v96, v96, v98
    s_waitcnt lgkmcnt(5)
    v_mfma_f32_16x16x32_bf16 v[144:147], a[96:99], v[72:75], v[144:147]
    ds_read_b128 v[48:51], v18 offset:40960
    v_and_b32 v98, v89, v91
    v_or3_b32 v97, v97, v89, v91
    v_mfma_f32_16x16x32_bf16 v[148:151], a[100:103], v[72:75], v[148:151]
    v_and_b32 v96, v96, v98
    s_lshl2_add_u32 s15, s99, s5
    buffer_load_dwordx4 a[216:219], v1, s[40:43], s15 offen offset:2048 sc1
    s_waitcnt lgkmcnt(5)
    v_mfma_f32_16x16x32_bf16 v[152:155], a[96:99], v[76:79], v[152:155]
    ds_read_b128 v[52:55], v19 offset:40960
    v_and_b32 v98, v93, v95
    v_or3_b32 v97, v97, v93, v95
    v_mfma_f32_16x16x32_bf16 v[156:159], a[100:103], v[76:79], v[156:159]
    v_and_b32 v96, v96, v98
    s_waitcnt lgkmcnt(5)
    v_mfma_f32_16x16x32_bf16 v[128:131], a[108:111], v[32:35], v[128:131]
    ds_read_b128 v[56:59], v13 offset:40960
    v_xor_b32 v96, s27, v96
    s_lshl2_add_u32 s15, s99, s5
    buffer_load_dwordx4 a[220:223], v1, s[40:43], s15 offen offset:3072 sc1
    v_mfma_f32_16x16x32_bf16 v[132:135], a[112:115], v[32:35], v[132:135]
    v_xor_b32 v97, s27, v97
    v_or_b32 v96, v96, v97
    s_waitcnt lgkmcnt(5)
    v_mfma_f32_16x16x32_bf16 v[136:139], a[108:111], v[36:39], v[136:139]
    ds_read_b128 v[60:63], v17 offset:40960
    v_and_b32 v96, 0x80000001, v96
    v_cmp_ne_u32 vcc, 0, v96
    s_cbranch_vccz pld_interleave_layers__ssm_conv_h3__dense_activation_relu__prompt_kernel_18
    s_mov_b32 s6, 100000
pl_interleave_layers__ssm_conv_h3__dense_activation_relu__prompt_kernel_17:
    buffer_load_dwordx2 v[80:81], v12, s[40:43], 0 offen offset:0 sc1
    buffer_load_dwordx2 v[82:83], v12, s[40:43], 0 offen offset:1024 sc1
    buffer_load_dwordx2 v[84:85], v12, s[40:43], 0 offen offset:2048 sc1
    buffer_load_dwordx2 v[86:87], v12, s[40:43], 0 offen offset:3072 sc1
    buffer_load_dwordx2 v[88:89], v12, s[40:43], s13 offen offset:0 sc1
    buffer_load_dwordx2 v[90:91], v12, s[40:43], s13 offen offset:1024 sc1
    buffer_load_dwordx2 v[92:93], v12, s[40:43], s13 offen offset:2048 sc1
    buffer_load_dwordx2 v[94:95], v12, s[40:43], s13 offen offset:3072 sc1
    s_waitcnt vmcnt(0)
    v_and_b32 v96, v81, v83
    v_or_b32 v97, v81, v83
    v_and_b32 v98, v85, v87
    v_or3_b32 v97, v97, v85, v87
    v_and_b32 v96, v96, v98
    v_and_b32 v98, v89, v91
    v_or3_b32 v97, v97, v89, v91
    v_and_b32 v96, v96, v98
    v_and_b32 v98, v93, v95
    v_or3_b32 v97, v97, v93, v95
    v_and_b32 v96, v96, v98
    v_xor_b32 v96, s27, v96
    v_xor_b32 v97, s27, v97
    v_or_b32 v96, v96, v97
    v_and_b32 v96, 0x80000001, v96
    v_cmp_ne_u32 vcc, 0, v96
    s_cbranch_vccz pld_interleave_layers__ssm_conv_h3__dense_activation_relu__prompt_kernel_18
    s_sub_u32 s6, s6, 1
    s_cmp_lg_u32 s6, 0
    s_cbranch_scc1 pl_interleave_layers__ssm_conv_h3__dense_activation_relu__prompt_kernel_17
pld_interleave_layers__ssm_conv_h3__dense_activation_relu__prompt_kernel_18:
    v_mfma_f32_16x16x32_bf16 v[140:143], a[112:115], v[36:39], v[140:143]
    s_lshl2_add_u32 s15, s100, s5
    buffer_load_dwordx4 a[224:227], v1, s[40:43], s15 offen offset:0 sc1
    v_add_f32 v80, v80, v82
    s_waitcnt lgkmcnt(5)
    v_mfma_f32_16x16x32_bf16 v[144:147], a[108:111], v[40:43], v[144:147]
    ds_read_b128 v[64:67], v18 offset:45056
    v_add_f32 v81, |v81|, |v83|
    v_add_f32 v84, v84, v86
    v_mfma_f32_16x16x32_bf16 v[148:151], a[112:115], v[40:43], v[148:151]
    v_add_f32 v85, |v85|, |v87|
    s_lshl2_add_u32 s15, s100, s5
    buffer_load_dwordx4 a[228:231], v1, s[40:43], s15 offen offset:1024 sc1
    s_waitcnt lgkmcnt(5)
    v_mfma_f32_16x16x32_bf16 v[152:155], a[108:111], v[44:47], v[152:155]
    ds_read_b128 v[68:71], v19 offset:45056
    v_add_f32 v88, v88, v90
    v_add_f32 v89, |v89|, |v91|
    v_mfma_f32_16x16x32_bf16 v[156:159], a[112:115], v[44:47], v[156:159]
    v_add_f32 v92, v92, v94
    s_waitcnt lgkmcnt(5)
    v_mfma_f32_16x16x32_bf16 v[128:131], a[120:123], v[48:51], v[128:131]
    ds_read_b128 v[72:75], v13 offset:45056
    v_add_f32 v93, |v93|, |v95|
    s_lshl2_add_u32 s15, s100, s5
    buffer_load_dwordx4 a[232:235], v1, s[40:43], s15 offen offset:2048 sc1
    v_mfma_f32_16x16x32_bf16 v[132:135], a[124:127], v[48:51], v[132:135]
    v_add_f32 v80, v80, v84
    v_add_f32 v81, v81, v85
    s_waitcnt lgkmcnt(5)
    v_mfma_f32_16x16x32_bf16 v[136:139], a[120:123], v[52:55], v[136:139]
    ds_read_b128 v[76:79], v17 offset:45056
    v_add_f32 v88, v88, v92
    v_add_f32 v89, v89, v93
    v_mfma_f32_16x16x32_bf16 v[140:143], a[124:127], v[52:55], v[140:143]
    s_lshl2_add_u32 s15, s100, s5
    buffer_load_dwordx4 a[236:239], v1, s[40:43], s15 offen offset:3072 sc1
    v_add_f32 v80, v80, v88
    s_waitcnt lgkmcnt(5)
    v_mfma_f32_16x16x32_bf16 v[144:147], a[120:123], v[56:59], v[144:147]
    ds_read_b128 v[32:35], v18 offset:49152
    v_add_f32 v81, v81, v89
    v_mul_f32 v82, s29, v80
    v_mfma_f32_16x16x32_bf16 v[148:151], a[124:127], v[56:59], v[148:151]
    v_mul_f32 v83, v82, v82
    s_lshl2_add_u32 s15, s101, s5
    buffer_load_dwordx4 a[240:243], v1, s[40:43], s15 offen offset:0 sc1
    s_waitcnt lgkmcnt(5)
    v_mfma_f32_16x16x32_bf16 v[152:155], a[120:123], v[60:63], v[152:155]
    ds_read_b128 v[36:39], v18 offset:53248
    v_fma_f32 v83, v81, s29, -v83
    v_max_f32 v83, 0, v83
    v_mfma_f32_16x16x32_bf16 v[156:159], a[124:127], v[60:63], v[156:159]
    v_add_f32 v83, 0x3727c5ac, v83
    s_waitcnt lgkmcnt(5)
    v_mfma_f32_16x16x32_bf16 v[128:131], a[132:135], v[64:67], v[128:131]
    ds_read_b128 v[40:43], v18 offset:57344
    v_rsq_f32 v84, v83
    s_lshl2_add_u32 s15, s101, s5
    buffer_load_dwordx4 a[244:247], v1, s[40:43], s15 offen offset:1024 sc1
    v_mfma_f32_16x16x32_bf16 v[132:135], a[136:139], v[64:67], v[132:135]
    v_sub_f32 v82, 0, v82
    v_xor_b32 v86, 64, v27
    s_waitcnt lgkmcnt(5)
    v_mfma_f32_16x16x32_bf16 v[136:139], a[132:135], v[68:71], v[136:139]
    ds_read_b128 v[44:47], v18 offset:61440
    v_xor_b32 v87, 128, v27
    v_mfma_f32_16x16x32_bf16 v[140:143], a[136:139], v[68:71], v[140:143]
    s_lshl2_add_u32 s15, s101, s5
    buffer_load_dwordx4 a[248:251], v1, s[40:43], s15 offen offset:2048 sc1
    v_xor_b32 v88, 192, v27
    s_waitcnt lgkmcnt(5)
    v_mfma_f32_16x16x32_bf16 v[144:147], a[132:135], v[72:75], v[144:147]
    ds_read_b128 v[48:51], v19 offset:49152
    ds_bpermute_b32 v14, v27, v84
    ds_bpermute_b32 v96, v27, v82
    v_mfma_f32_16x16x32_bf16 v[148:151], a[136:139], v[72:75], v[148:151]
    s_lshl2_add_u32 s15, s101, s5
    buffer_load_dwordx4 a[252:255], v1, s[40:43], s15 offen offset:3072 sc1
    s_waitcnt lgkmcnt(7)
    v_mfma_f32_16x16x32_bf16 v[152:155], a[132:135], v[76:79], v[152:155]
    ds_read_b128 v[52:55], v19 offset:53248
    ds_bpermute_b32 v97, v86, v82
    ds_bpermute_b32 v98, v87, v82
    v_mfma_f32_16x16x32_bf16 v[156:159], a[136:139], v[76:79], v[156:159]
    ds_bpermute_b32 v99, v88, v82
    s_waitcnt lgkmcnt(0)
    v_mfma_f32_16x16x32_bf16 v[128:131], a[144:147], v[32:35], v[128:131]
    ds_read_b128 v[56:59], v19 offset:57344
    v_fmac_f32 v136, v112, v97
    s_lshl2_add_u32 s15, s20, s5
    buffer_load_dwordx4 v[192:195], v1, s[40:43], s15 offen offset:0 sc1
    v_fmac_f32 v137, v113, v97
    v_mfma_f32_16x16x32_bf16 v[132:135], a[148:151], v[32:35], v[132:135]
    v_fmac_f32 v138, v114, v97
    v_fmac_f32 v139, v115, v97
    v_mfma_f32_16x16x32_bf16 v[128:131], a[156:159], v[36:39], v[128:131]
    ds_read_b128 v[60:63], v19 offset:61440
    v_fmac_f32 v140, v116, v97
    v_fmac_f32 v141, v117, v97
    v_mfma_f32_16x16x32_bf16 v[132:135], a[160:163], v[36:39], v[132:135]
    v_fmac_f32 v142, v118, v97
    v_fmac_f32 v143, v119, v97
    v_mfma_f32_16x16x32_bf16 v[128:131], a[168:171], v[40:43], v[128:131]
    ds_read_b128 v[64:67], v13 offset:49152
    v_fmac_f32 v144, v112, v98
    s_lshl2_add_u32 s15, s20, s5
    buffer_load_dwordx4 v[196:199], v1, s[40:43], s15 offen offset:1024 sc1
    v_fmac_f32 v145, v113, v98
    v_mfma_f32_16x16x32_bf16 v[132:135], a[172:175], v[40:43], v[132:135]
    v_fmac_f32 v146, v114, v98
    v_fmac_f32 v147, v115, v98
    v_mfma_f32_16x16x32_bf16 v[128:131], a[180:183], v[44:47], v[128:131]
    ds_read_b128 v[68:71], v13 offset:53248
    v_fmac_f32 v148, v116, v98
    v_fmac_f32 v149, v117, v98
    v_mfma_f32_16x16x32_bf16 v[132:135], a[184:187], v[44:47], v[132:135]
    v_fmac_f32 v150, v118, v98
    v_fmac_f32 v151, v119, v98
    v_mfma_f32_16x16x32_bf16 v[136:139], a[144:147], v[48:51], v[136:139]
    ds_read_b128 v[72:75], v13 offset:57344
    v_mfma_f32_16x16x32_bf16 v[140:143], a[148:151], v[48:51], v[140:143]
    v_mfma_f32_16x16x32_bf16 v[136:139], a[156:159], v[52:55], v[136:139]
    ds_read_b128 v[76:79], v13 offset:61440
    v_mfma_f32_16x16x32_bf16 v[140:143], a[160:163], v[52:55], v[140:143]
    v_fmac_f32 v128, v112, v96
    s_lshl2_add_u32 s15, s20, s5
    buffer_load_dwordx4 v[200:203], v1, s[40:43], s15 offen offset:2048 sc1
    v_fmac_f32 v129, v113, v96
    v_fmac_f32 v130, v114, v96
    s_waitcnt lgkmcnt(5)
    v_mfma_f32_16x16x32_bf16 v[136:139], a[168:171], v[56:59], v[136:139]
    ds_read_b128 v[32:35], v17 offset:49152
    v_fmac_f32 v131, v115, v96
    v_fmac_f32 v132, v116, v96
    v_fmac_f32 v133, v117, v96
    v_fmac_f32 v134, v118, v96
    v_mfma_f32_16x16x32_bf16 v[140:143], a[172:175], v[56:59], v[140:143]
    v_fmac_f32 v135, v119, v96
    v_cvt_pk_bf16_f32 v128, v128, v129
    s_lshl2_add_u32 s15, s20, s5
    buffer_load_dwordx4 v[204:207], v1, s[40:43], s15 offen offset:3072 sc1
    v_cvt_pk_bf16_f32 v129, v130, v131
    s_waitcnt lgkmcnt(5)
    v_mfma_f32_16x16x32_bf16 v[136:139], a[180:183], v[60:63], v[136:139]
    ds_read_b128 v[36:39], v17 offset:53248
    v_cvt_pk_bf16_f32 v130, v132, v133
    v_cvt_pk_bf16_f32 v131, v134, v135
    v_pk_max_i16 v128, v128, 0
    v_pk_max_i16 v129, v129, 0
    v_mfma_f32_16x16x32_bf16 v[140:143], a[184:187], v[60:63], v[140:143]
    v_pk_max_i16 v130, v130, 0
    v_pk_max_i16 v131, v131, 0
    buffer_store_dwordx4 v[128:131], v8, s[40:43], s48 offen
    s_waitcnt lgkmcnt(5)
    v_mfma_f32_16x16x32_bf16 v[144:147], a[144:147], v[64:67], v[144:147]
    ds_read_b128 v[40:43], v17 offset:57344
    v_fmac_f32 v152, v112, v99
    s_lshl2_add_u32 s15, s21, s5
    buffer_load_dwordx4 v[208:211], v1, s[40:43], s15 offen offset:0 sc1
    v_fmac_f32 v153, v113, v99
    v_mfma_f32_16x16x32_bf16 v[148:151], a[148:151], v[64:67], v[148:151]
    v_fmac_f32 v154, v114, v99
    v_fmac_f32 v155, v115, v99
    s_waitcnt lgkmcnt(5)
    v_mfma_f32_16x16x32_bf16 v[144:147], a[156:159], v[68:71], v[144:147]
    ds_read_b128 v[44:47], v17 offset:61440
    v_fmac_f32 v156, v116, v99
    v_fmac_f32 v157, v117, v99
    v_fmac_f32 v158, v118, v99
    v_mfma_f32_16x16x32_bf16 v[148:151], a[160:163], v[68:71], v[148:151]
    v_fmac_f32 v159, v119, v99
    v_cvt_pk_bf16_f32 v136, v136, v137
    s_waitcnt lgkmcnt(5)
    v_mfma_f32_16x16x32_bf16 v[144:147], a[168:171], v[72:75], v[144:147]
    ds_read_b128 v[48:51], v18 offset:24576
    s_lshl2_add_u32 s15, s21, s5
    buffer_load_dwordx4 v[212:215], v1, s[40:43], s15 offen offset:1024 sc1
    v_cvt_pk_bf16_f32 v137, v138, v139
    v_mfma_f32_16x16x32_bf16 v[148:151], a[172:175], v[72:75], v[148:151]
    v_cvt_pk_bf16_f32 v138, v140, v141
    v_cvt_pk_bf16_f32 v139, v142, v143
    v_pk_max_i16 v136, v136, 0
    s_waitcnt lgkmcnt(5)
    v_mfma_f32_16x16x32_bf16 v[144:147], a[180:183], v[76:79], v[144:147]
    ds_read_b128 v[52:55], v18 offset:28672
    v_pk_max_i16 v137, v137, 0
    v_pk_max_i16 v138, v138, 0
    v_mfma_f32_16x16x32_bf16 v[148:151], a[184:187], v[76:79], v[148:151]
    v_pk_max_i16 v139, v139, 0
    buffer_store_dwordx4 v[136:139], v8, s[40:43], s49 offen
    s_waitcnt lgkmcnt(5)
    v_mfma_f32_16x16x32_bf16 v[152:155], a[144:147], v[32:35], v[152:155]
    ds_read_b128 v[56:59], v18 offset:32768
    v_mfma_f32_16x16x32_bf16 v[156:159], a[148:151], v[32:35], v[156:159]
    s_waitcnt lgkmcnt(5)
    v_mfma_f32_16x16x32_bf16 v[152:155], a[156:159], v[36:39], v[152:155]
    ds_read_b128 v[60:63], v18 offset:36864
    v_mfma_f32_16x16x32_bf16 v[156:159], a[160:163], v[36:39], v[156:159]
    v_cvt_pk_bf16_f32 v144, v144, v145
    s_lshl2_add_u32 s15, s21, s5
    buffer_load_dwordx4 v[216:219], v1, s[40:43], s15 offen offset:2048 sc1
    v_cvt_pk_bf16_f32 v145, v146, v147
    s_waitcnt lgkmcnt(5)
    v_mfma_f32_16x16x32_bf16 v[152:155], a[168:171], v[40:43], v[152:155]
    ds_read_b128 v[64:67], v18 offset:40960
    v_cvt_pk_bf16_f32 v146, v148, v149
    v_cvt_pk_bf16_f32 v147, v150, v151
    v_mfma_f32_16x16x32_bf16 v[156:159], a[172:175], v[40:43], v[156:159]
    v_pk_max_i16 v144, v144, 0
    s_lshl2_add_u32 s15, s21, s5
    buffer_load_dwordx4 v[220:223], v1, s[40:43], s15 offen offset:3072 sc1
    s_waitcnt lgkmcnt(5)
    v_mfma_f32_16x16x32_bf16 v[152:155], a[180:183], v[44:47], v[152:155]
    ds_read_b128 v[68:71], v18 offset:45056
    v_pk_max_i16 v145, v145, 0
    v_pk_max_i16 v146, v146, 0
    v_mfma_f32_16x16x32_bf16 v[156:159], a[184:187], v[44:47], v[156:159]
    v_pk_max_i16 v147, v147, 0
    buffer_store_dwordx4 v[144:147], v8, s[40:43], s50 offen
    s_waitcnt lgkmcnt(5)
    v_mfma_f32_16x16x32_bf16 v[160:163], a[80:83], v[48:51], v[160:163]
    ds_read_b128 v[72:75], v18 offset:49152
    s_waitcnt lgkmcnt(5)
    v_mfma_f32_16x16x32_bf16 v[160:163], a[92:95], v[52:55], v[160:163]
    ds_read_b128 v[76:79], v18 offset:53248
    s_waitcnt lgkmcnt(5)
    v_mfma_f32_16x16x32_bf16 v[160:163], a[104:107], v[56:59], v[160:163]
    ds_read_b128 v[32:35], v18 offset:57344
    v_cvt_pk_bf16_f32 v152, v152, v153
    v_cvt_pk_bf16_f32 v153, v154, v155
    s_waitcnt lgkmcnt(5)
    v_mfma_f32_16x16x32_bf16 v[160:163], a[116:119], v[60:63], v[160:163]
    ds_read_b128 v[36:39], v18 offset:61440
    v_cvt_pk_bf16_f32 v154, v156, v157
    s_waitcnt lgkmcnt(5)
    v_mfma_f32_16x16x32_bf16 v[160:163], a[128:131], v[64:67], v[160:163]
    ds_read_b128 v[40:43], v19 offset:24576
    v_cvt_pk_bf16_f32 v155, v158, v159
    v_pk_max_i16 v152, v152, 0
    s_waitcnt lgkmcnt(5)
    v_mfma_f32_16x16x32_bf16 v[160:163], a[140:143], v[68:71], v[160:163]
    ds_read_b128 v[44:47], v19 offset:28672
    v_pk_max_i16 v153, v153, 0
    s_waitcnt lgkmcnt(5)
    v_mfma_f32_16x16x32_bf16 v[160:163], a[152:155], v[72:75], v[160:163]
    ds_read_b128 v[48:51], v19 offset:32768
    v_pk_max_i16 v154, v154, 0
    v_pk_max_i16 v155, v155, 0
    s_waitcnt lgkmcnt(5)
    v_mfma_f32_16x16x32_bf16 v[160:163], a[164:167], v[76:79], v[160:163]
    ds_read_b128 v[52:55], v19 offset:36864
    buffer_store_dwordx4 v[152:155], v8, s[40:43], s51 offen
    s_waitcnt lgkmcnt(5)
    v_mfma_f32_16x16x32_bf16 v[160:163], a[176:179], v[32:35], v[160:163]
    ds_read_b128 v[56:59], v19 offset:40960
    s_lshl2_add_u32 s15, s22, s5
    buffer_load_dwordx4 v[224:227], v26, s[40:43], s15 offen offset:0 sc1
    s_waitcnt lgkmcnt(5)
    v_mfma_f32_16x16x32_bf16 v[160:163], a[188:191], v[36:39], v[160:163]
    ds_read_b128 v[60:63], v19 offset:45056
    s_waitcnt lgkmcnt(5)
    v_mfma_f32_16x16x32_bf16 v[164:167], a[80:83], v[40:43], v[164:167]
    ds_read_b128 v[64:67], v19 offset:49152
    s_lshl2_add_u32 s15, s22, s5
    buffer_load_dwordx4 v[228:231], v26, s[40:43], s15 offen offset:1024 sc1
    s_waitcnt lgkmcnt(5)
    v_mfma_f32_16x16x32_bf16 v[164:167], a[92:95], v[44:47], v[164:167]
    ds_read_b128 v[68:71], v19 offset:53248
    s_waitcnt lgkmcnt(5)
    v_mfma_f32_16x16x32_bf16 v[164:167], a[104:107], v[48:51], v[164:167]
    ds_read_b128 v[72:75], v19 offset:57344
    v_fmac_f32 v160, v120, v96
    v_fmac_f32 v161, v121, v96
    s_waitcnt lgkmcnt(5)
    v_mfma_f32_16x16x32_bf16 v[164:167], a[116:119], v[52:55], v[164:167]
    ds_read_b128 v[76:79], v19 offset:61440
    v_fmac_f32 v162, v122, v96
    s_lshl2_add_u32 s15, s22, s5
    buffer_load_dwordx4 v[232:235], v26, s[40:43], s15 offen offset:2048 sc1
    s_waitcnt lgkmcnt(5)
    v_mfma_f32_16x16x32_bf16 v[164:167], a[128:131], v[56:59], v[164:167]
    ds_read_b128 v[32:35], v13 offset:24576
    v_fmac_f32 v163, v123, v96
    v_cvt_pk_bf16_f32 v160, v160, v161
    s_waitcnt lgkmcnt(5)
    v_mfma_f32_16x16x32_bf16 v[164:167], a[140:143], v[60:63], v[164:167]
    ds_read_b128 v[36:39], v13 offset:28672
    v_cvt_pk_bf16_f32 v161, v162, v163
    s_lshl2_add_u32 s15, s22, s5
    buffer_load_dwordx4 v[236:239], v26, s[40:43], s15 offen offset:3072 sc1
    s_waitcnt lgkmcnt(5)
    v_mfma_f32_16x16x32_bf16 v[164:167], a[152:155], v[64:67], v[164:167]
    ds_read_b128 v[40:43], v13 offset:32768
    v_pk_max_i16 v160, v160, 0
    v_pk_max_i16 v161, v161, 0
    s_waitcnt lgkmcnt(5)
    v_mfma_f32_16x16x32_bf16 v[164:167], a[164:167], v[68:71], v[164:167]
    ds_read_b128 v[44:47], v13 offset:36864
    buffer_store_dwordx2 v[160:161], v9, s[40:43], s48 offen
    s_waitcnt lgkmcnt(5)
    v_mfma_f32_16x16x32_bf16 v[164:167], a[176:179], v[72:75], v[164:167]
    ds_read_b128 v[48:51], v13 offset:40960
    s_waitcnt vmcnt(5)
    s_add_u32 s30, s30, 1
    v_mov_b32 v100, s30
    s_barrier
    s_cmp_eq_u32 s26, 0
    s_cbranch_scc1 slow_interleave_layers__ssm_conv_h3__dense_activation_relu__prompt_kernel_19
    buffer_store_dword v100, v7, s[40:43], 0 offen offset:384
    s_branch pub_interleave_layers__ssm_conv_h3__dense_activation_relu__prompt_kernel_20
slow_interleave_layers__ssm_conv_h3__dense_activation_relu__prompt_kernel_19:
    s_waitcnt vmcnt(0)
    s_cmp_lg_u32 s4, 0
    s_cbranch_scc1 pub_interleave_layers__ssm_conv_h3__dense_activation_relu__prompt_kernel_20
    buffer_wbl2 sc1
    s_waitcnt vmcnt(0)
    buffer_store_dword v100, v7, s[40:43], 0 offen offset:384 sc1
pub_interleave_layers__ssm_conv_h3__dense_activation_relu__prompt_kernel_20:
    s_waitcnt lgkmcnt(5)
    v_mfma_f32_16x16x32_bf16 v[164:167], a[188:191], v[76:79], v[164:167]
    ds_read_b128 v[52:55], v13 offset:45056
    s_waitcnt lgkmcnt(5)
    v_mfma_f32_16x16x32_bf16 v[168:171], a[80:83], v[32:35], v[168:171]
    ds_read_b128 v[56:59], v13 offset:49152
    s_waitcnt lgkmcnt(5)
    v_mfma_f32_16x16x32_bf16 v[168:171], a[92:95], v[36:39], v[168:171]
    ds_read_b128 v[60:63], v13 offset:53248
    s_waitcnt lgkmcnt(5)
    v_mfma_f32_16x16x32_bf16 v[168:171], a[104:107], v[40:43], v[168:171]
    ds_read_b128 v[64:67], v13 offset:57344
    v_fmac_f32 v164, v120, v97
    v_fmac_f32 v165, v121, v97
    s_waitcnt lgkmcnt(5)
    v_mfma_f32_16x16x32_bf16 v[168:171], a[116:119], v[44:47], v[168:171]
    ds_read_b128 v[68:71], v13 offset:61440
    v_fmac_f32 v166, v122, v97
    s_waitcnt lgkmcnt(5)
    v_mfma_f32_16x16x32_bf16 v[168:171], a[128:131], v[48:51], v[168:171]
    ds_read_b128 v[72:75], v17 offset:24576
    v_fmac_f32 v167, v123, v97
    v_cvt_pk_bf16_f32 v164, v164, v165
    s_waitcnt lgkmcnt(5)
    v_mfma_f32_16x16x32_bf16 v[168:171], a[140:143], v[52:55], v[168:171]
    ds_read_b128 v[76:79], v17 offset:28672
    v_cvt_pk_bf16_f32 v165, v166, v167
    s_waitcnt lgkmcnt(5)
    v_mfma_f32_16x16x32_bf16 v[168:171], a[152:155], v[56:59], v[168:171]
    ds_read_b128 v[32:35], v17 offset:32768
    v_pk_max_i16 v164, v164, 0
    v_pk_max_i16 v165, v165, 0
    s_waitcnt lgkmcnt(5)
    v_mfma_f32_16x16x32_bf16 v[168:171], a[164:167], v[60:63], v[168:171]
    ds_read_b128 v[36:39], v17 offset:36864
    buffer_store_dwordx2 v[164:165], v9, s[40:43], s49 offen
    s_waitcnt lgkmcnt(5)
    v_mfma_f32_16x16x32_bf16 v[168:171], a[176:179], v[64:67], v[168:171]
    ds_read_b128 v[40:43], v17 offset:40960
    s_waitcnt lgkmcnt(5)
    v_mfma_f32_16x16x32_bf16 v[168:171], a[188:191], v[68:71], v[168:171]
    ds_read_b128 v[44:47], v17 offset:45056
    s_waitcnt lgkmcnt(5)
    v_mfma_f32_16x16x32_bf16 v[172:175], a[80:83], v[72:75], v[172:175]
    ds_read_b128 v[48:51], v17 offset:49152
    s_waitcnt lgkmcnt(5)
    v_mfma_f32_16x16x32_bf16 v[172:175], a[92:95], v[76:79], v[172:175]
    ds_read_b128 v[52:55], v17 offset:53248
    s_waitcnt lgkmcnt(5)
    v_mfma_f32_16x16x32_bf16 v[172:175], a[104:107], v[32:35], v[172:175]
    ds_read_b128 v[56:59], v17 offset:57344
    v_fmac_f32 v168, v120, v98
    v_fmac_f32 v169, v121, v98
    s_waitcnt lgkmcnt(5)
    v_mfma_f32_16x16x32_bf16 v[172:175], a[116:119], v[36:39], v[172:175]
    ds_read_b128 v[60:63], v17 offset:61440
    v_fmac_f32 v170, v122, v98
    buffer_load_dword v189, v28, s[40:43], s12 offen sc1
    s_waitcnt lgkmcnt(5)
    v_mfma_f32_16x16x32_bf16 v[172:175], a[128:131], v[40:43], v[172:175]
    v_fmac_f32 v171, v123, v98
    v_cvt_pk_bf16_f32 v168, v168, v169
    s_waitcnt lgkmcnt(4)
    v_mfma_f32_16x16x32_bf16 v[172:175], a[140:143], v[44:47], v[172:175]
    v_cvt_pk_bf16_f32 v169, v170, v171
    s_waitcnt lgkmcnt(3)
    v_mfma_f32_16x16x32_bf16 v[172:175], a[152:155], v[48:51], v[172:175]
    v_pk_max_i16 v168, v168, 0
    v_pk_max_i16 v169, v169, 0
    s_waitcnt lgkmcnt(2)
    v_mfma_f32_16x16x32_bf16 v[172:175], a[164:167], v[52:55], v[172:175]
    buffer_store_dwordx2 v[168:169], v9, s[40:43], s50 offen
    s_waitcnt lgkmcnt(1)
    v_mfma_f32_16x16x32_bf16 v[172:175], a[176:179], v[56:59], v[172:175]
    s_waitcnt lgkmcnt(0)
    v_mfma_f32_16x16x32_bf16 v[172:175], a[188:191], v[60:63], v[172:175]
    s_waitcnt vmcnt(1)
    v_cmp_gt_u32 vcc, s30, v189
    s_cbranch_vccz apd_interleave_layers__ssm_conv_h3__dense_activation_relu__prompt_kernel_21
    s_mov_b32 s6, 100000
poll_interleave_layers__ssm_conv_h3__dense_activation_relu__prompt_kernel_22:
    buffer_load_dword v189, v28, s[40:43], s12 offen sc1
    s_waitcnt vmcnt(0)
    v_cmp_gt_u32 vcc, s30, v189
    s_cbranch_vccz done_interleave_layers__ssm_conv_h3__dense_activation_relu__prompt_kernel_23
    s_sub_u32 s6, s6, 1
    s_cmp_lg_u32 s6, 0
    s_cbranch_scc1 poll_interleave_layers__ssm_conv_h3__dense_activation_relu__prompt_kernel_22
done_interleave_layers__ssm_conv_h3__dense_activation_relu__prompt_kernel_23:
apd_interleave_layers__ssm_conv_h3__dense_activation_relu__prompt_kernel_21:
    s_cmp_lg_u32 s26, 0
    s_cbranch_scc1 acq_interleave_layers__ssm_conv_h3__dense_activation_relu__prompt_kernel_24
    buffer_inv sc1
    s_waitcnt vmcnt(0)
acq_interleave_layers__ssm_conv_h3__dense_activation_relu__prompt_kernel_24:
    s_nop 2
    v_fmac_f32 v172, v120, v99
    s_add_u32 s15, s32, s95
    buffer_load_dwordx4 v[132:135], v1, s[40:43], s15 offen sc1
    v_fmac_f32 v173, v121, v99
    v_fmac_f32 v174, v122, v99
    v_fmac_f32 v175, v123, v99
    v_cvt_pk_bf16_f32 v172, v172, v173
    s_add_u32 s15, s33, s95
    buffer_load_dwordx4 v[140:143], v1, s[40:43], s15 offen sc1
    v_cvt_pk_bf16_f32 v173, v174, v175
    v_pk_max_i16 v172, v172, 0
    v_pk_max_i16 v173, v173, 0
    buffer_store_dwordx2 v[172:173], v9, s[40:43], s51 offen
    s_add_u32 s15, s34, s95
    buffer_load_dwordx4 v[148:151], v1, s[40:43], s15 offen sc1
    ds_read_b128 v[176:179], v30 offset:0
    ds_read_b128 v[180:183], v30 offset:1024
    ds_read_b128 v[184:187], v30 offset:2048
    ds_read_b128 v[188:191], v30 offset:3072
    s_add_u32 s15, s35, s95
    buffer_load_dwordx4 v[156:159], v1, s[40:43], s15 offen sc1
    ds_read_b128 v[240:243], v30 offset:4096
    ds_read_b128 v[244:247], v30 offset:5120
    ds_read_b128 v[248:251], v30 offset:6144
    ds_read_b128 v[252:255], v30 offset:7168
    s_branch L_g1e
L_g1b:
    s_waitcnt lgkmcnt(5)
    v_mfma_f32_16x16x32_bf16 v[128:131], a[24:27], v[64:67], v[128:131]
    ds_read_b128 v[40:43], v13 offset:12288
    s_add_u32 m0, m0, 4096
    s_add_u32 s24, s24, 4096
    s_and_b32 s24, s24, 0xffff
    buffer_load_dwordx4 v24, s[44:47], s24 offen sc1 lds
    v_mfma_f32_16x16x32_bf16 v[132:135], a[28:31], v[64:67], v[132:135]
    v_mfma_f32_16x16x32_bf16 v[160:163], a[32:35], v[64:67], v[160:163]
    s_waitcnt lgkmcnt(5)
    v_mfma_f32_16x16x32_bf16 v[136:139], a[24:27], v[68:71], v[136:139]
    ds_read_b128 v[44:47], v17 offset:12288
    v_mfma_f32_16x16x32_bf16 v[140:143], a[28:31], v[68:71], v[140:143]
    s_add_u32 m0, m0, 4096
    s_add_u32 s24, s24, 4096
    s_and_b32 s24, s24, 0xffff
    buffer_load_dwordx4 v24, s[44:47], s24 offen sc1 lds
    v_mfma_f32_16x16x32_bf16 v[164:167], a[32:35], v[68:71], v[164:167]
    s_waitcnt lgkmcnt(5)
    v_mfma_f32_16x16x32_bf16 v[144:147], a[24:27], v[72:75], v[144:147]
    ds_read_b128 v[48:51], v18 offset:16384
    v_mfma_f32_16x16x32_bf16 v[148:151], a[28:31], v[72:75], v[148:151]
    v_mfma_f32_16x16x32_bf16 v[168:171], a[32:35], v[72:75], v[168:171]
    s_add_u32 m0, m0, 4096
    s_add_u32 s24, s24, 4096
    s_and_b32 s24, s24, 0xffff
    buffer_load_dwordx4 v24, s[44:47], s24 offen sc1 lds
    s_waitcnt lgkmcnt(5)
    v_mfma_f32_16x16x32_bf16 v[152:155], a[24:27], v[76:79], v[152:155]
    ds_read_b128 v[52:55], v19 offset:16384
    v_mfma_f32_16x16x32_bf16 v[156:159], a[28:31], v[76:79], v[156:159]
    v_mfma_f32_16x16x32_bf16 v[172:175], a[32:35], v[76:79], v[172:175]
    s_waitcnt lgkmcnt(5)
    v_mfma_f32_16x16x32_bf16 v[128:131], a[36:39], v[32:35], v[128:131]
    ds_read_b128 v[56:59], v13 offset:16384
    s_add_u32 m0, m0, 4096
    s_add_u32 s24, s24, 4096
    s_and_b32 s24, s24, 0xffff
    buffer_load_dwordx4 v24, s[44:47], s24 offen sc1 lds
    v_mfma_f32_16x16x32_bf16 v[132:135], a[40:43], v[32:35], v[132:135]
    v_mfma_f32_16x16x32_bf16 v[160:163], a[44:47], v[32:35], v[160:163]
    s_waitcnt lgkmcnt(5)
    v_mfma_f32_16x16x32_bf16 v[136:139], a[36:39], v[36:39], v[136:139]
    ds_read_b128 v[60:63], v17 offset:16384
    v_mfma_f32_16x16x32_bf16 v[140:143], a[40:43], v[36:39], v[140:143]
    s_add_u32 m0, m0, 4096
    s_add_u32 s24, s24, 4096
    s_and_b32 s24, s24, 0xffff
    buffer_load_dwordx4 v24, s[44:47], s24 offen sc1 lds
    v_mfma_f32_16x16x32_bf16 v[164:167], a[44:47], v[36:39], v[164:167]
    s_waitcnt lgkmcnt(5)
    v_mfma_f32_16x16x32_bf16 v[144:147], a[36:39], v[40:43], v[144:147]
    ds_read_b128 v[64:67], v18 offset:20480
    v_mfma_f32_16x16x32_bf16 v[148:151], a[40:43], v[40:43], v[148:151]
    v_mfma_f32_16x16x32_bf16 v[168:171], a[44:47], v[40:43], v[168:171]
    s_add_u32 m0, m0, 4096
    s_add_u32 s24, s24, 4096
    s_and_b32 s24, s24, 0xffff
    buffer_load_dwordx4 v24, s[44:47], s24 offen sc1 lds
    s_waitcnt lgkmcnt(5)
    v_mfma_f32_16x16x32_bf16 v[152:155], a[36:39], v[44:47], v[152:155]
    ds_read_b128 v[68:71], v19 offset:20480
    v_mfma_f32_16x16x32_bf16 v[156:159], a[40:43], v[44:47], v[156:159]
    v_mfma_f32_16x16x32_bf16 v[172:175], a[44:47], v[44:47], v[172:175]
    s_waitcnt vmcnt(6)
    s_barrier
    s_waitcnt lgkmcnt(5)
    v_mfma_f32_16x16x32_bf16 v[128:131], a[48:51], v[48:51], v[128:131]
    ds_read_b128 v[72:75], v13 offset:20480
    buffer_load_dwordx2 v[80:81], v12, s[40:43], 0 offen offset:0 sc1
    buffer_load_dwordx2 v[82:83], v12, s[40:43], 0 offen offset:1024 sc1
    v_mfma_f32_16x16x32_bf16 v[132:135], a[52:55], v[48:51], v[132:135]
    v_mfma_f32_16x16x32_bf16 v[160:163], a[56:59], v[48:51], v[160:163]
    s_waitcnt lgkmcnt(5)
    v_mfma_f32_16x16x32_bf16 v[136:139], a[48:51], v[52:55], v[136:139]
    ds_read_b128 v[76:79], v17 offset:20480
    v_mfma_f32_16x16x32_bf16 v[140:143], a[52:55], v[52:55], v[140:143]
    v_mfma_f32_16x16x32_bf16 v[164:167], a[56:59], v[52:55], v[164:167]
    s_waitcnt lgkmcnt(5)
    v_mfma_f32_16x16x32_bf16 v[144:147], a[48:51], v[56:59], v[144:147]
    ds_read_b128 v[32:35], v18 offset:24576
    buffer_load_dwordx2 v[84:85], v12, s[40:43], 0 offen offset:2048 sc1
    buffer_load_dwordx2 v[86:87], v12, s[40:43], 0 offen offset:3072 sc1
    v_mfma_f32_16x16x32_bf16 v[148:151], a[52:55], v[56:59], v[148:151]
    v_mfma_f32_16x16x32_bf16 v[168:171], a[56:59], v[56:59], v[168:171]
    s_waitcnt lgkmcnt(5)
    v_mfma_f32_16x16x32_bf16 v[152:155], a[48:51], v[60:63], v[152:155]
    ds_read_b128 v[36:39], v19 offset:24576
    v_mfma_f32_16x16x32_bf16 v[156:159], a[52:55], v[60:63], v[156:159]
    v_mfma_f32_16x16x32_bf16 v[172:175], a[56:59], v[60:63], v[172:175]
    s_waitcnt lgkmcnt(5)
    v_mfma_f32_16x16x32_bf16 v[128:131], a[60:63], v[64:67], v[128:131]
    ds_read_b128 v[40:43], v13 offset:24576
    buffer_load_dwordx2 v[88:89], v12, s[40:43], s13 offen offset:0 sc1
    buffer_load_dwordx2 v[90:91], v12, s[40:43], s13 offen offset:1024 sc1
    v_mfma_f32_16x16x32_bf16 v[132:135], a[64:67], v[64:67], v[132:135]
    v_mfma_f32_16x16x32_bf16 v[160:163], a[68:71], v[64:67], v[160:163]
    s_waitcnt lgkmcnt(5)
    v_mfma_f32_16x16x32_bf16 v[136:139], a[60:63], v[68:71], v[136:139]
    ds_read_b128 v[44:47], v17 offset:24576
    v_mfma_f32_16x16x32_bf16 v[140:143], a[64:67], v[68:71], v[140:143]
    v_mfma_f32_16x16x32_bf16 v[164:167], a[68:71], v[68:71], v[164:167]
    s_waitcnt lgkmcnt(5)
    v_mfma_f32_16x16x32_bf16 v[144:147], a[60:63], v[72:75], v[144:147]
    ds_read_b128 v[48:51], v18 offset:28672
    buffer_load_dwordx2 v[92:93], v12, s[40:43], s13 offen offset:2048 sc1
    buffer_load_dwordx2 v[94:95], v12, s[40:43], s13 offen offset:3072 sc1
    v_mfma_f32_16x16x32_bf16 v[148:151], a[64:67], v[72:75], v[148:151]
    v_mfma_f32_16x16x32_bf16 v[168:171], a[68:71], v[72:75], v[168:171]
    s_waitcnt lgkmcnt(5)
    v_mfma_f32_16x16x32_bf16 v[152:155], a[60:63], v[76:79], v[152:155]
    ds_read_b128 v[52:55], v19 offset:28672
    v_mfma_f32_16x16x32_bf16 v[156:159], a[64:67], v[76:79], v[156:159]
    v_mfma_f32_16x16x32_bf16 v[172:175], a[68:71], v[76:79], v[172:175]
    s_waitcnt lgkmcnt(5)
    v_mfma_f32_16x16x32_bf16 v[128:131], a[72:75], v[32:35], v[128:131]
    ds_read_b128 v[56:59], v13 offset:28672
    v_mfma_f32_16x16x32_bf16 v[132:135], a[76:79], v[32:35], v[132:135]
    s_waitcnt lgkmcnt(5)
    v_mfma_f32_16x16x32_bf16 v[136:139], a[72:75], v[36:39], v[136:139]
    ds_read_b128 v[60:63], v17 offset:28672
    v_mfma_f32_16x16x32_bf16 v[140:143], a[76:79], v[36:39], v[140:143]
    s_waitcnt lgkmcnt(5)
    v_mfma_f32_16x16x32_bf16 v[144:147], a[72:75], v[40:43], v[144:147]
    ds_read_b128 v[64:67], v18 offset:32768
    v_mfma_f32_16x16x32_bf16 v[148:151], a[76:79], v[40:43], v[148:151]
    s_waitcnt lgkmcnt(5)
    v_mfma_f32_16x16x32_bf16 v[152:155], a[72:75], v[44:47], v[152:155]
    ds_read_b128 v[68:71], v19 offset:32768
    v_mfma_f32_16x16x32_bf16 v[156:159], a[76:79], v[44:47], v[156:159]
    s_waitcnt lgkmcnt(5)
    v_mfma_f32_16x16x32_bf16 v[128:131], a[84:87], v[48:51], v[128:131]
    ds_read_b128 v[72:75], v13 offset:32768
    v_mfma_f32_16x16x32_bf16 v[132:135], a[88:91], v[48:51], v[132:135]
    s_waitcnt lgkmcnt(5)
    v_mfma_f32_16x16x32_bf16 v[136:139], a[84:87], v[52:55], v[136:139]
    ds_read_b128 v[76:79], v17 offset:32768
    v_mfma_f32_16x16x32_bf16 v[140:143], a[88:91], v[52:55], v[140:143]
    s_waitcnt lgkmcnt(5)
    v_mfma_f32_16x16x32_bf16 v[144:147], a[84:87], v[56:59], v[144:147]
    ds_read_b128 v[32:35], v18 offset:36864
    v_mfma_f32_16x16x32_bf16 v[148:151], a[88:91], v[56:59], v[148:151]
    s_waitcnt lgkmcnt(5)
    v_mfma_f32_16x16x32_bf16 v[152:155], a[84:87], v[60:63], v[152:155]
    ds_read_b128 v[36:39], v19 offset:36864
    v_mfma_f32_16x16x32_bf16 v[156:159], a[88:91], v[60:63], v[156:159]
    s_waitcnt vmcnt(8)
    s_barrier
    s_waitcnt lgkmcnt(5)
    v_mfma_f32_16x16x32_bf16 v[128:131], a[96:99], v[64:67], v[128:131]
    ds_read_b128 v[40:43], v13 offset:36864
    s_waitcnt vmcnt(0)
    v_and_b32 v96, v81, v83
    v_mfma_f32_16x16x32_bf16 v[132:135], a[100:103], v[64:67], v[132:135]
    v_or_b32 v97, v81, v83
    s_waitcnt lgkmcnt(5)
    v_mfma_f32_16x16x32_bf16 v[136:139], a[96:99], v[68:71], v[136:139]
    ds_read_b128 v[44:47], v17 offset:36864
    v_and_b32 v98, v85, v87
    v_or3_b32 v97, v97, v85, v87
    v_mfma_f32_16x16x32_bf16 v[140:143], a[100:103], v[68:71], v[140:143]
    v_and_b32 v96, v96, v98
    s_waitcnt lgkmcnt(5)
    v_mfma_f32_16x16x32_bf16 v[144:147], a[96:99], v[72:75], v[144:147]
    ds_read_b128 v[48:51], v18 offset:40960
    v_and_b32 v98, v89, v91
    v_or3_b32 v97, v97, v89, v91
    v_mfma_f32_16x16x32_bf16 v[148:151], a[100:103], v[72:75], v[148:151]
    v_and_b32 v96, v96, v98
    s_waitcnt lgkmcnt(5)
    v_mfma_f32_16x16x32_bf16 v[152:155], a[96:99], v[76:79], v[152:155]
    ds_read_b128 v[52:55], v19 offset:40960
    v_and_b32 v98, v93, v95
    v_or3_b32 v97, v97, v93, v95
    v_mfma_f32_16x16x32_bf16 v[156:159], a[100:103], v[76:79], v[156:159]
    v_and_b32 v96, v96, v98
    s_waitcnt lgkmcnt(5)
    v_mfma_f32_16x16x32_bf16 v[128:131], a[108:111], v[32:35], v[128:131]
    ds_read_b128 v[56:59], v13 offset:40960
    v_xor_b32 v96, s27, v96
    v_xor_b32 v97, s27, v97
    v_mfma_f32_16x16x32_bf16 v[132:135], a[112:115], v[32:35], v[132:135]
    v_or_b32 v96, v96, v97
    s_waitcnt lgkmcnt(5)
    v_mfma_f32_16x16x32_bf16 v[136:139], a[108:111], v[36:39], v[136:139]
    ds_read_b128 v[60:63], v17 offset:40960
    v_and_b32 v96, 0x80000001, v96
    v_cmp_ne_u32 vcc, 0, v96
    s_cbranch_vccz pld_interleave_layers__ssm_conv_h3__dense_activation_relu__prompt_kernel_26
    s_mov_b32 s6, 100000
pl_interleave_layers__ssm_conv_h3__dense_activation_relu__prompt_kernel_25:
    buffer_load_dwordx2 v[80:81], v12, s[40:43], 0 offen offset:0 sc1
    buffer_load_dwordx2 v[82:83], v12, s[40:43], 0 offen offset:1024 sc1
    buffer_load_dwordx2 v[84:85], v12, s[40:43], 0 offen offset:2048 sc1
    buffer_load_dwordx2 v[86:87], v12, s[40:43], 0 offen offset:3072 sc1
    buffer_load_dwordx2 v[88:89], v12, s[40:43], s13 offen offset:0 sc1
    buffer_load_dwordx2 v[90:91], v12, s[40:43], s13 offen offset:1024 sc1
    buffer_load_dwordx2 v[92:93], v12, s[40:43], s13 offen offset:2048 sc1
    buffer_load_dwordx2 v[94:95], v12, s[40:43], s13 offen offset:3072 sc1
    s_waitcnt vmcnt(0)
    v_and_b32 v96, v81, v83
    v_or_b32 v97, v81, v83
    v_and_b32 v98, v85, v87
    v_or3_b32 v97, v97, v85, v87
    v_and_b32 v96, v96, v98
    v_and_b32 v98, v89, v91
    v_or3_b32 v97, v97, v89, v91
    v_and_b32 v96, v96, v98
    v_and_b32 v98, v93, v95
    v_or3_b32 v97, v97, v93, v95
    v_and_b32 v96, v96, v98
    v_xor_b32 v96, s27, v96
    v_xor_b32 v97, s27, v97
    v_or_b32 v96, v96, v97
    v_and_b32 v96, 0x80000001, v96
    v_cmp_ne_u32 vcc, 0, v96
    s_cbranch_vccz pld_interleave_layers__ssm_conv_h3__dense_activation_relu__prompt_kernel_26
    s_sub_u32 s6, s6, 1
    s_cmp_lg_u32 s6, 0
    s_cbranch_scc1 pl_interleave_layers__ssm_conv_h3__dense_activation_relu__prompt_kernel_25
pld_interleave_layers__ssm_conv_h3__dense_activation_relu__prompt_kernel_26:
    v_mfma_f32_16x16x32_bf16 v[140:143], a[112:115], v[36:39], v[140:143]
    v_add_f32 v80, v80, v82
    s_waitcnt lgkmcnt(5)
    v_mfma_f32_16x16x32_bf16 v[144:147], a[108:111], v[40:43], v[144:147]
    ds_read_b128 v[64:67], v18 offset:45056
    v_add_f32 v81, |v81|, |v83|
    v_add_f32 v84, v84, v86
    v_mfma_f32_16x16x32_bf16 v[148:151], a[112:115], v[40:43], v[148:151]
    v_add_f32 v85, |v85|, |v87|
    s_waitcnt lgkmcnt(5)
    v_mfma_f32_16x16x32_bf16 v[152:155], a[108:111], v[44:47], v[152:155]
    ds_read_b128 v[68:71], v19 offset:45056
    v_add_f32 v88, v88, v90
    v_add_f32 v89, |v89|, |v91|
    v_mfma_f32_16x16x32_bf16 v[156:159], a[112:115], v[44:47], v[156:159]
    v_add_f32 v92, v92, v94
    s_waitcnt lgkmcnt(5)
    v_mfma_f32_16x16x32_bf16 v[128:131], a[120:123], v[48:51], v[128:131]
    ds_read_b128 v[72:75], v13 offset:45056
    v_add_f32 v93, |v93|, |v95|
    v_add_f32 v80, v80, v84
    v_mfma_f32_16x16x32_bf16 v[132:135], a[124:127], v[48:51], v[132:135]
    v_add_f32 v81, v81, v85
    s_waitcnt lgkmcnt(5)
    v_mfma_f32_16x16x32_bf16 v[136:139], a[120:123], v[52:55], v[136:139]
    ds_read_b128 v[76:79], v17 offset:45056
    v_add_f32 v88, v88, v92
    v_add_f32 v89, v89, v93
    v_mfma_f32_16x16x32_bf16 v[140:143], a[124:127], v[52:55], v[140:143]
    v_add_f32 v80, v80, v88
    s_waitcnt lgkmcnt(5)
    v_mfma_f32_16x16x32_bf16 v[144:147], a[120:123], v[56:59], v[144:147]
    ds_read_b128 v[32:35], v18 offset:49152
    v_add_f32 v81, v81, v89
    v_mul_f32 v82, s29, v80
    v_mfma_f32_16x16x32_bf16 v[148:151], a[124:127], v[56:59], v[148:151]
    v_mul_f32 v83, v82, v82
    s_waitcnt lgkmcnt(5)
    v_mfma_f32_16x16x32_bf16 v[152:155], a[120:123], v[60:63], v[152:155]
    ds_read_b128 v[36:39], v18 offset:53248
    v_fma_f32 v83, v81, s29, -v83
    v_max_f32 v83, 0, v83
    v_mfma_f32_16x16x32_bf16 v[156:159], a[124:127], v[60:63], v[156:159]
    v_add_f32 v83, 0x3727c5ac, v83
    s_waitcnt lgkmcnt(5)
    v_mfma_f32_16x16x32_bf16 v[128:131], a[132:135], v[64:67], v[128:131]
    ds_read_b128 v[40:43], v18 offset:57344
    v_rsq_f32 v84, v83
    v_sub_f32 v82, 0, v82
    v_mfma_f32_16x16x32_bf16 v[132:135], a[136:139], v[64:67], v[132:135]
    v_xor_b32 v86, 64, v27
    s_waitcnt lgkmcnt(5)
    v_mfma_f32_16x16x32_bf16 v[136:139], a[132:135], v[68:71], v[136:139]
    ds_read_b128 v[44:47], v18 offset:61440
    v_xor_b32 v87, 128, v27
    v_mfma_f32_16x16x32_bf16 v[140:143], a[136:139], v[68:71], v[140:143]
    v_xor_b32 v88, 192, v27
    s_waitcnt lgkmcnt(5)
    v_mfma_f32_16x16x32_bf16 v[144:147], a[132:135], v[72:75], v[144:147]
    ds_read_b128 v[48:51], v19 offset:49152
    ds_bpermute_b32 v14, v27, v84
    ds_bpermute_b32 v96, v27, v82
    v_mfma_f32_16x16x32_bf16 v[148:151], a[136:139], v[72:75], v[148:151]
    ds_bpermute_b32 v97, v86, v82
    s_waitcnt lgkmcnt(8)
    v_mfma_f32_16x16x32_bf16 v[152:155], a[132:135], v[76:79], v[152:155]
    ds_read_b128 v[52:55], v19 offset:53248
    ds_bpermute_b32 v98, v87, v82
    v_mfma_f32_16x16x32_bf16 v[156:159], a[136:139], v[76:79], v[156:159]
    ds_bpermute_b32 v99, v88, v82
    s_waitcnt lgkmcnt(0)
    v_mfma_f32_16x16x32_bf16 v[128:131], a[144:147], v[32:35], v[128:131]
    ds_read_b128 v[56:59], v19 offset:57344
    v_fmac_f32 v136, v112, v97
    v_fmac_f32 v137, v113, v97
    v_mfma_f32_16x16x32_bf16 v[132:135], a[148:151], v[32:35], v[132:135]
    v_fmac_f32 v138, v114, v97
    v_fmac_f32 v139, v115, v97
    v_mfma_f32_16x16x32_bf16 v[128:131], a[156:159], v[36:39], v[128:131]
    ds_read_b128 v[60:63], v19 offset:61440
    v_fmac_f32 v140, v116, v97
    v_fmac_f32 v141, v117, v97
    v_mfma_f32_16x16x32_bf16 v[132:135], a[160:163], v[36:39], v[132:135]
    v_fmac_f32 v142, v118, v97
    v_fmac_f32 v143, v119, v97
    v_mfma_f32_16x16x32_bf16 v[128:131], a[168:171], v[40:43], v[128:131]
    ds_read_b128 v[64:67], v13 offset:49152
    v_fmac_f32 v144, v112, v98
    v_fmac_f32 v145, v113, v98
    v_mfma_f32_16x16x32_bf16 v[132:135], a[172:175], v[40:43], v[132:135]
    v_fmac_f32 v146, v114, v98
    v_fmac_f32 v147, v115, v98
    v_mfma_f32_16x16x32_bf16 v[128:131], a[180:183], v[44:47], v[128:131]
    ds_read_b128 v[68:71], v13 offset:53248
    v_fmac_f32 v148, v116, v98
    v_fmac_f32 v149, v117, v98
    v_mfma_f32_16x16x32_bf16 v[132:135], a[184:187], v[44:47], v[132:135]
    v_fmac_f32 v150, v118, v98
    v_fmac_f32 v151, v119, v98
    v_mfma_f32_16x16x32_bf16 v[136:139], a[144:147], v[48:51], v[136:139]
    ds_read_b128 v[72:75], v13 offset:57344
    v_mfma_f32_16x16x32_bf16 v[140:143], a[148:151], v[48:51], v[140:143]
    v_mfma_f32_16x16x32_bf16 v[136:139], a[156:159], v[52:55], v[136:139]
    ds_read_b128 v[76:79], v13 offset:61440
    v_mfma_f32_16x16x32_bf16 v[140:143], a[160:163], v[52:55], v[140:143]
    v_fmac_f32 v128, v112, v96
    v_fmac_f32 v129, v113, v96
    v_fmac_f32 v130, v114, v96
    v_fmac_f32 v131, v115, v96
    s_waitcnt lgkmcnt(5)
    v_mfma_f32_16x16x32_bf16 v[136:139], a[168:171], v[56:59], v[136:139]
    ds_read_b128 v[32:35], v17 offset:49152
    v_fmac_f32 v132, v116, v96
    v_fmac_f32 v133, v117, v96
    v_fmac_f32 v134, v118, v96
    v_mfma_f32_16x16x32_bf16 v[140:143], a[172:175], v[56:59], v[140:143]
    v_fmac_f32 v135, v119, v96
    v_cvt_pk_bf16_f32 v128, v128, v129
    v_cvt_pk_bf16_f32 v129, v130, v131
    v_cvt_pk_bf16_f32 v130, v132, v133
    s_waitcnt lgkmcnt(5)
    v_mfma_f32_16x16x32_bf16 v[136:139], a[180:183], v[60:63], v[136:139]
    ds_read_b128 v[36:39], v17 offset:53248
    v_cvt_pk_bf16_f32 v131, v134, v135
    v_pk_max_i16 v128, v128, 0
    v_pk_max_i16 v129, v129, 0
    v_mfma_f32_16x16x32_bf16 v[140:143], a[184:187], v[60:63], v[140:143]
    v_pk_max_i16 v130, v130, 0
    v_pk_max_i16 v131, v131, 0
    buffer_store_dwordx4 v[128:131], v8, s[40:43], s48 offen
    s_waitcnt lgkmcnt(5)
    v_mfma_f32_16x16x32_bf16 v[144:147], a[144:147], v[64:67], v[144:147]
    ds_read_b128 v[40:43], v17 offset:57344
    v_fmac_f32 v152, v112, v99
    v_fmac_f32 v153, v113, v99
    v_fmac_f32 v154, v114, v99
    v_mfma_f32_16x16x32_bf16 v[148:151], a[148:151], v[64:67], v[148:151]
    v_fmac_f32 v155, v115, v99
    v_fmac_f32 v156, v116, v99
    s_waitcnt lgkmcnt(5)
    v_mfma_f32_16x16x32_bf16 v[144:147], a[156:159], v[68:71], v[144:147]
    ds_read_b128 v[44:47], v17 offset:61440
    v_fmac_f32 v157, v117, v99
    v_fmac_f32 v158, v118, v99
    v_mfma_f32_16x16x32_bf16 v[148:151], a[160:163], v[68:71], v[148:151]
    v_fmac_f32 v159, v119, v99
    v_cvt_pk_bf16_f32 v136, v136, v137
    s_waitcnt lgkmcnt(5)
    v_mfma_f32_16x16x32_bf16 v[144:147], a[168:171], v[72:75], v[144:147]
    ds_read_b128 v[48:51], v18 offset:24576
    v_cvt_pk_bf16_f32 v137, v138, v139
    v_cvt_pk_bf16_f32 v138, v140, v141
    v_mfma_f32_16x16x32_bf16 v[148:151], a[172:175], v[72:75], v[148:151]
    v_cvt_pk_bf16_f32 v139, v142, v143
    v_pk_max_i16 v136, v136, 0
    s_waitcnt lgkmcnt(5)
    v_mfma_f32_16x16x32_bf16 v[144:147], a[180:183], v[76:79], v[144:147]
    ds_read_b128 v[52:55], v18 offset:28672
    v_pk_max_i16 v137, v137, 0
    v_pk_max_i16 v138, v138, 0
    v_mfma_f32_16x16x32_bf16 v[148:151], a[184:187], v[76:79], v[148:151]
    v_pk_max_i16 v139, v139, 0
    buffer_store_dwordx4 v[136:139], v8, s[40:43], s49 offen
    s_waitcnt lgkmcnt(5)
    v_mfma_f32_16x16x32_bf16 v[152:155], a[144:147], v[32:35], v[152:155]
    ds_read_b128 v[56:59], v18 offset:32768
    v_mfma_f32_16x16x32_bf16 v[156:159], a[148:151], v[32:35], v[156:159]
    s_waitcnt lgkmcnt(5)
    v_mfma_f32_16x16x32_bf16 v[152:155], a[156:159], v[36:39], v[152:155]
    ds_read_b128 v[60:63], v18 offset:36864
    v_mfma_f32_16x16x32_bf16 v[156:159], a[160:163], v[36:39], v[156:159]
    v_cvt_pk_bf16_f32 v144, v144, v145
    v_cvt_pk_bf16_f32 v145, v146, v147
    s_waitcnt lgkmcnt(5)
    v_mfma_f32_16x16x32_bf16 v[152:155], a[168:171], v[40:43], v[152:155]
    ds_read_b128 v[64:67], v18 offset:40960
    v_cvt_pk_bf16_f32 v146, v148, v149
    v_cvt_pk_bf16_f32 v147, v150, v151
    v_mfma_f32_16x16x32_bf16 v[156:159], a[172:175], v[40:43], v[156:159]
    v_pk_max_i16 v144, v144, 0
    v_pk_max_i16 v145, v145, 0
    s_waitcnt lgkmcnt(5)
    v_mfma_f32_16x16x32_bf16 v[152:155], a[180:183], v[44:47], v[152:155]
    ds_read_b128 v[68:71], v18 offset:45056
    v_pk_max_i16 v146, v146, 0
    v_pk_max_i16 v147, v147, 0
    v_mfma_f32_16x16x32_bf16 v[156:159], a[184:187], v[44:47], v[156:159]
    buffer_store_dwordx4 v[144:147], v8, s[40:43], s50 offen
    s_waitcnt lgkmcnt(5)
    v_mfma_f32_16x16x32_bf16 v[160:163], a[80:83], v[48:51], v[160:163]
    ds_read_b128 v[72:75], v18 offset:49152
    s_waitcnt lgkmcnt(5)
    v_mfma_f32_16x16x32_bf16 v[160:163], a[92:95], v[52:55], v[160:163]
    ds_read_b128 v[76:79], v18 offset:53248
    s_waitcnt lgkmcnt(5)
    v_mfma_f32_16x16x32_bf16 v[160:163], a[104:107], v[56:59], v[160:163]
    ds_read_b128 v[32:35], v18 offset:57344
    v_cvt_pk_bf16_f32 v152, v152, v153
    v_cvt_pk_bf16_f32 v153, v154, v155
    s_waitcnt lgkmcnt(5)
    v_mfma_f32_16x16x32_bf16 v[160:163], a[116:119], v[60:63], v[160:163]
    ds_read_b128 v[36:39], v18 offset:61440
    v_cvt_pk_bf16_f32 v154, v156, v157
    s_waitcnt lgkmcnt(5)
    v_mfma_f32_16x16x32_bf16 v[160:163], a[128:131], v[64:67], v[160:163]
    ds_read_b128 v[40:43], v19 offset:24576
    v_cvt_pk_bf16_f32 v155, v158, v159
    v_pk_max_i16 v152, v152, 0
    s_waitcnt lgkmcnt(5)
    v_mfma_f32_16x16x32_bf16 v[160:163], a[140:143], v[68:71], v[160:163]
    ds_read_b128 v[44:47], v19 offset:28672
    v_pk_max_i16 v153, v153, 0
    s_waitcnt lgkmcnt(5)
    v_mfma_f32_16x16x32_bf16 v[160:163], a[152:155], v[72:75], v[160:163]
    ds_read_b128 v[48:51], v19 offset:32768
    v_pk_max_i16 v154, v154, 0
    v_pk_max_i16 v155, v155, 0
    s_waitcnt lgkmcnt(5)
    v_mfma_f32_16x16x32_bf16 v[160:163], a[164:167], v[76:79], v[160:163]
    ds_read_b128 v[52:55], v19 offset:36864
    buffer_store_dwordx4 v[152:155], v8, s[40:43], s51 offen
    s_waitcnt lgkmcnt(5)
    v_mfma_f32_16x16x32_bf16 v[160:163], a[176:179], v[32:35], v[160:163]
    ds_read_b128 v[56:59], v19 offset:40960
    s_waitcnt lgkmcnt(5)
    v_mfma_f32_16x16x32_bf16 v[160:163], a[188:191], v[36:39], v[160:163]
    ds_read_b128 v[60:63], v19 offset:45056
    s_waitcnt lgkmcnt(5)
    v_mfma_f32_16x16x32_bf16 v[164:167], a[80:83], v[40:43], v[164:167]
    ds_read_b128 v[64:67], v19 offset:49152
    s_waitcnt lgkmcnt(5)
    v_mfma_f32_16x16x32_bf16 v[164:167], a[92:95], v[44:47], v[164:167]
    ds_read_b128 v[68:71], v19 offset:53248
    s_waitcnt lgkmcnt(5)
    v_mfma_f32_16x16x32_bf16 v[164:167], a[104:107], v[48:51], v[164:167]
    ds_read_b128 v[72:75], v19 offset:57344
    v_fmac_f32 v160, v120, v96
    v_fmac_f32 v161, v121, v96
    s_waitcnt lgkmcnt(5)
    v_mfma_f32_16x16x32_bf16 v[164:167], a[116:119], v[52:55], v[164:167]
    ds_read_b128 v[76:79], v19 offset:61440
    v_fmac_f32 v162, v122, v96
    s_waitcnt lgkmcnt(5)
    v_mfma_f32_16x16x32_bf16 v[164:167], a[128:131], v[56:59], v[164:167]
    ds_read_b128 v[32:35], v13 offset:24576
    v_fmac_f32 v163, v123, v96
    v_cvt_pk_bf16_f32 v160, v160, v161
    s_waitcnt lgkmcnt(5)
    v_mfma_f32_16x16x32_bf16 v[164:167], a[140:143], v[60:63], v[164:167]
    ds_read_b128 v[36:39], v13 offset:28672
    v_cvt_pk_bf16_f32 v161, v162, v163
    s_waitcnt lgkmcnt(5)
    v_mfma_f32_16x16x32_bf16 v[164:167], a[152:155], v[64:67], v[164:167]
    ds_read_b128 v[40:43], v13 offset:32768
    v_pk_max_i16 v160, v160, 0
    v_pk_max_i16 v161, v161, 0
    s_waitcnt lgkmcnt(5)
    v_mfma_f32_16x16x32_bf16 v[164:167], a[164:167], v[68:71], v[164:167]
    ds_read_b128 v[44:47], v13 offset:36864
    buffer_store_dwordx2 v[160:161], v9, s[40:43], s48 offen
    s_waitcnt lgkmcnt(5)
    v_mfma_f32_16x16x32_bf16 v[164:167], a[176:179], v[72:75], v[164:167]
    ds_read_b128 v[48:51], v13 offset:40960
    s_waitcnt vmcnt(1)
    s_add_u32 s30, s30, 1
    v_mov_b32 v100, s30
    s_barrier
    s_cmp_eq_u32 s26, 0
    s_cbranch_scc1 slow_interleave_layers__ssm_conv_h3__dense_activation_relu__prompt_kernel_27
    buffer_store_dword v100, v7, s[40:43], 0 offen offset:384
    s_branch pub_interleave_layers__ssm_conv_h3__dense_activation_relu__prompt_kernel_28
slow_interleave_layers__ssm_conv_h3__dense_activation_relu__prompt_kernel_27:
    s_waitcnt vmcnt(0)
    s_cmp_lg_u32 s4, 0
    s_cbranch_scc1 pub_interleave_layers__ssm_conv_h3__dense_activation_relu__prompt_kernel_28
    buffer_wbl2 sc1
    s_waitcnt vmcnt(0)
    buffer_store_dword v100, v7, s[40:43], 0 offen offset:384 sc1
pub_interleave_layers__ssm_conv_h3__dense_activation_relu__prompt_kernel_28:
    s_waitcnt lgkmcnt(5)
    v_mfma_f32_16x16x32_bf16 v[164:167], a[188:191], v[76:79], v[164:167]
    ds_read_b128 v[52:55], v13 offset:45056
    s_waitcnt lgkmcnt(5)
    v_mfma_f32_16x16x32_bf16 v[168:171], a[80:83], v[32:35], v[168:171]
    ds_read_b128 v[56:59], v13 offset:49152
    s_waitcnt lgkmcnt(5)
    v_mfma_f32_16x16x32_bf16 v[168:171], a[92:95], v[36:39], v[168:171]
    ds_read_b128 v[60:63], v13 offset:53248
    s_waitcnt lgkmcnt(5)
    v_mfma_f32_16x16x32_bf16 v[168:171], a[104:107], v[40:43], v[168:171]
    ds_read_b128 v[64:67], v13 offset:57344
    v_fmac_f32 v164, v120, v97
    v_fmac_f32 v165, v121, v97
    s_waitcnt lgkmcnt(5)
    v_mfma_f32_16x16x32_bf16 v[168:171], a[116:119], v[44:47], v[168:171]
    ds_read_b128 v[68:71], v13 offset:61440
    v_fmac_f32 v166, v122, v97
    s_waitcnt lgkmcnt(5)
    v_mfma_f32_16x16x32_bf16 v[168:171], a[128:131], v[48:51], v[168:171]
    ds_read_b128 v[72:75], v17 offset:24576
    v_fmac_f32 v167, v123, v97
    v_cvt_pk_bf16_f32 v164, v164, v165
    s_waitcnt lgkmcnt(5)
    v_mfma_f32_16x16x32_bf16 v[168:171], a[140:143], v[52:55], v[168:171]
    ds_read_b128 v[76:79], v17 offset:28672
    v_cvt_pk_bf16_f32 v165, v166, v167
    s_waitcnt lgkmcnt(5)
    v_mfma_f32_16x16x32_bf16 v[168:171], a[152:155], v[56:59], v[168:171]
    ds_read_b128 v[32:35], v17 offset:32768
    v_pk_max_i16 v164, v164, 0
    v_pk_max_i16 v165, v165, 0
    s_waitcnt lgkmcnt(5)
    v_mfma_f32_16x16x32_bf16 v[168:171], a[164:167], v[60:63], v[168:171]
    ds_read_b128 v[36:39], v17 offset:36864
    buffer_store_dwordx2 v[164:165], v9, s[40:43], s49 offen
    s_waitcnt lgkmcnt(5)
    v_mfma_f32_16x16x32_bf16 v[168:171], a[176:179], v[64:67], v[168:171]
    ds_read_b128 v[40:43], v17 offset:40960
    s_waitcnt lgkmcnt(5)
    v_mfma_f32_16x16x32_bf16 v[168:171], a[188:191], v[68:71], v[168:171]
    ds_read_b128 v[44:47], v17 offset:45056
    s_waitcnt lgkmcnt(5)
    v_mfma_f32_16x16x32_bf16 v[172:175], a[80:83], v[72:75], v[172:175]
    ds_read_b128 v[48:51], v17 offset:49152
    s_waitcnt lgkmcnt(5)
    v_mfma_f32_16x16x32_bf16 v[172:175], a[92:95], v[76:79], v[172:175]
    ds_read_b128 v[52:55], v17 offset:53248
    s_waitcnt lgkmcnt(5)
    v_mfma_f32_16x16x32_bf16 v[172:175], a[104:107], v[32:35], v[172:175]
    ds_read_b128 v[56:59], v17 offset:57344
    v_fmac_f32 v168, v120, v98
    v_fmac_f32 v169, v121, v98
    s_waitcnt lgkmcnt(5)
    v_mfma_f32_16x16x32_bf16 v[172:175], a[116:119], v[36:39], v[172:175]
    ds_read_b128 v[60:63], v17 offset:61440
    v_fmac_f32 v170, v122, v98
    buffer_load_dword v189, v28, s[40:43], s12 offen sc1
    s_waitcnt lgkmcnt(5)
    v_mfma_f32_16x16x32_bf16 v[172:175], a[128:131], v[40:43], v[172:175]
    v_fmac_f32 v171, v123, v98
    v_cvt_pk_bf16_f32 v168, v168, v169
    s_waitcnt lgkmcnt(4)
    v_mfma_f32_16x16x32_bf16 v[172:175], a[140:143], v[44:47], v[172:175]
    v_cvt_pk_bf16_f32 v169, v170, v171
    s_waitcnt lgkmcnt(3)
    v_mfma_f32_16x16x32_bf16 v[172:175], a[152:155], v[48:51], v[172:175]
    v_pk_max_i16 v168, v168, 0
    v_pk_max_i16 v169, v169, 0
    s_waitcnt lgkmcnt(2)
    v_mfma_f32_16x16x32_bf16 v[172:175], a[164:167], v[52:55], v[172:175]
    buffer_store_dwordx2 v[168:169], v9, s[40:43], s50 offen
    s_waitcnt lgkmcnt(1)
    v_mfma_f32_16x16x32_bf16 v[172:175], a[176:179], v[56:59], v[172:175]
    s_waitcnt lgkmcnt(0)
    v_mfma_f32_16x16x32_bf16 v[172:175], a[188:191], v[60:63], v[172:175]
    s_waitcnt vmcnt(1)
    v_cmp_gt_u32 vcc, s30, v189
    s_cbranch_vccz apd_interleave_layers__ssm_conv_h3__dense_activation_relu__prompt_kernel_29
    s_mov_b32 s6, 100000
poll_interleave_layers__ssm_conv_h3__dense_activation_relu__prompt_kernel_30:
    buffer_load_dword v189, v28, s[40:43], s12 offen sc1
    s_waitcnt vmcnt(0)
    v_cmp_gt_u32 vcc, s30, v189
    s_cbranch_vccz done_interleave_layers__ssm_conv_h3__dense_activation_relu__prompt_kernel_31
    s_sub_u32 s6, s6, 1
    s_cmp_lg_u32 s6, 0
    s_cbranch_scc1 poll_interleave_layers__ssm_conv_h3__dense_activation_relu__prompt_kernel_30
done_interleave_layers__ssm_conv_h3__dense_activation_relu__prompt_kernel_31:
apd_interleave_layers__ssm_conv_h3__dense_activation_relu__prompt_kernel_29:
    s_cmp_lg_u32 s26, 0
    s_cbranch_scc1 acq_interleave_layers__ssm_conv_h3__dense_activation_relu__prompt_kernel_32
    buffer_inv sc1
    s_waitcnt vmcnt(0)
acq_interleave_layers__ssm_conv_h3__dense_activation_relu__prompt_kernel_32:
    s_nop 2
    v_fmac_f32 v172, v120, v99
    s_add_u32 s15, s32, s95
    buffer_load_dwordx4 v[132:135], v1, s[40:43], s15 offen sc1
    v_fmac_f32 v173, v121, v99
    v_fmac_f32 v174, v122, v99
    v_fmac_f32 v175, v123, v99
    v_cvt_pk_bf16_f32 v172, v172, v173
    s_add_u32 s15, s33, s95
    buffer_load_dwordx4 v[140:143], v1, s[40:43], s15 offen sc1
    v_cvt_pk_bf16_f32 v173, v174, v175
    v_pk_max_i16 v172, v172, 0
    v_pk_max_i16 v173, v173, 0
    buffer_store_dwordx2 v[172:173], v9, s[40:43], s51 offen
    s_add_u32 s15, s34, s95
    buffer_load_dwordx4 v[148:151], v1, s[40:43], s15 offen sc1
    ds_read_b128 v[176:179], v30 offset:0
    ds_read_b128 v[180:183], v30 offset:1024
    ds_read_b128 v[184:187], v30 offset:2048
    ds_read_b128 v[188:191], v30 offset:3072
    s_add_u32 s15, s35, s95
    buffer_load_dwordx4 v[156:159], v1, s[40:43], s15 offen sc1
    ds_read_b128 v[240:243], v30 offset:4096
    ds_read_b128 v[244:247], v30 offset:5120
    ds_read_b128 v[248:251], v30 offset:6144
    ds_read_b128 v[252:255], v30 offset:7168
L_g1e:
    v_add_u32 v96, s56, v1
    v_add_u32 v97, s57, v1
    v_add_u32 v98, s58, v1
    v_add_u32 v99, s59, v1
    s_waitcnt lgkmcnt(4)
    v_mfma_f32_16x16x32_bf16 v[32:35], v[176:179], v[128:131], 0
    v_mfma_f32_16x16x32_bf16 v[36:39], v[180:183], v[128:131], 0
    v_mfma_f32_16x16x32_bf16 v[40:43], v[184:187], v[128:131], 0
    v_mfma_f32_16x16x32_bf16 v[44:47], v[188:191], v[128:131], 0
    v_mfma_f32_16x16x32_bf16 v[48:51], v[176:179], v[136:139], 0
    s_add_u32 s15, s32, s98
    buffer_load_dwordx4 v[128:131], v1, s[40:43], s15 offen sc1
    v_mfma_f32_16x16x32_bf16 v[52:55], v[180:183], v[136:139], 0
    v_mfma_f32_16x16x32_bf16 v[56:59], v[184:187], v[136:139], 0
    v_mfma_f32_16x16x32_bf16 v[60:63], v[188:191], v[136:139], 0
    v_mfma_f32_16x16x32_bf16 v[64:67], v[176:179], v[144:147], 0
    s_add_u32 s15, s33, s98
    buffer_load_dwordx4 v[136:139], v1, s[40:43], s15 offen sc1
    v_mfma_f32_16x16x32_bf16 v[68:71], v[180:183], v[144:147], 0
    v_mfma_f32_16x16x32_bf16 v[72:75], v[184:187], v[144:147], 0
    v_mfma_f32_16x16x32_bf16 v[76:79], v[188:191], v[144:147], 0
    v_mfma_f32_16x16x32_bf16 v[80:83], v[176:179], v[152:155], 0
    s_add_u32 s15, s34, s98
    buffer_load_dwordx4 v[144:147], v1, s[40:43], s15 offen sc1
    v_mfma_f32_16x16x32_bf16 v[84:87], v[180:183], v[152:155], 0
    v_mfma_f32_16x16x32_bf16 v[88:91], v[184:187], v[152:155], 0
    v_mfma_f32_16x16x32_bf16 v[92:95], v[188:191], v[152:155], 0
    s_waitcnt lgkmcnt(0)
    s_waitcnt vmcnt(7)
    v_mfma_f32_16x16x32_bf16 v[32:35], v[240:243], v[132:135], v[32:35]
    s_add_u32 s15, s35, s98
    buffer_load_dwordx4 v[152:155], v1, s[40:43], s15 offen sc1
    v_mfma_f32_16x16x32_bf16 v[36:39], v[244:247], v[132:135], v[36:39]
    v_mfma_f32_16x16x32_bf16 v[40:43], v[248:251], v[132:135], v[40:43]
    v_mfma_f32_16x16x32_bf16 v[44:47], v[252:255], v[132:135], v[44:47]
    s_waitcnt vmcnt(6)
    s_add_u32 s30, s30, 1
    v_mov_b32 v100, s30
    s_barrier
    s_cmp_eq_u32 s26, 0
    s_cbranch_scc1 slow_interleave_layers__ssm_conv_h3__dense_activation_relu__prompt_kernel_33
    buffer_store_dword v100, v7, s[40:43], 0 offen offset:384
    s_branch pub_interleave_layers__ssm_conv_h3__dense_activation_relu__prompt_kernel_34
slow_interleave_layers__ssm_conv_h3__dense_activation_relu__prompt_kernel_33:
    s_waitcnt vmcnt(0)
    s_cmp_lg_u32 s4, 0
    s_cbranch_scc1 pub_interleave_layers__ssm_conv_h3__dense_activation_relu__prompt_kernel_34
    buffer_wbl2 sc1
    s_waitcnt vmcnt(0)
    buffer_store_dword v100, v7, s[40:43], 0 offen offset:384 sc1
pub_interleave_layers__ssm_conv_h3__dense_activation_relu__prompt_kernel_34:
    v_mfma_f32_16x16x32_bf16 v[48:51], v[240:243], v[140:143], v[48:51]
    s_add_u32 s15, s32, s96
    buffer_load_dwordx4 v[132:135], v1, s[40:43], s15 offen sc1
    v_mfma_f32_16x16x32_bf16 v[52:55], v[244:247], v[140:143], v[52:55]
    ds_read_b128 v[176:179], v30 offset:8192
    v_mfma_f32_16x16x32_bf16 v[56:59], v[248:251], v[140:143], v[56:59]
    s_add_u32 s15, s33, s96
    buffer_load_dwordx4 v[160:163], v1, s[40:43], s15 offen sc1
    ds_read_b128 v[180:183], v30 offset:9216
    v_mfma_f32_16x16x32_bf16 v[60:63], v[252:255], v[140:143], v[60:63]
    ds_read_b128 v[184:187], v30 offset:10240
    s_waitcnt vmcnt(8)
    v_mfma_f32_16x16x32_bf16 v[64:67], v[240:243], v[148:151], v[64:67]
    s_add_u32 s15, s34, s96
    buffer_load_dwordx4 v[164:167], v1, s[40:43], s15 offen sc1
    v_mfma_f32_16x16x32_bf16 v[68:71], v[244:247], v[148:151], v[68:71]
    ds_read_b128 v[188:191], v30 offset:11264
    v_mfma_f32_16x16x32_bf16 v[72:75], v[248:251], v[148:151], v[72:75]
    v_mfma_f32_16x16x32_bf16 v[76:79], v[252:255], v[148:151], v[76:79]
    s_waitcnt vmcnt(8)
    v_mfma_f32_16x16x32_bf16 v[80:83], v[240:243], v[156:159], v[80:83]
    s_add_u32 s15, s35, s96
    buffer_load_dwordx4 v[168:171], v1, s[40:43], s15 offen sc1
    v_mfma_f32_16x16x32_bf16 v[84:87], v[244:247], v[156:159], v[84:87]
    v_mfma_f32_16x16x32_bf16 v[88:91], v[248:251], v[156:159], v[88:91]
    v_mfma_f32_16x16x32_bf16 v[92:95], v[252:255], v[156:159], v[92:95]
    s_waitcnt vmcnt(8)
    v_mfma_f32_16x16x32_bf16 v[32:35], a[192:195], v[128:131], v[32:35]
    s_add_u32 s15, s32, s99
    buffer_load_dwordx4 v[172:175], v1, s[40:43], s15 offen sc1
    v_mfma_f32_16x16x32_bf16 v[36:39], a[196:199], v[128:131], v[36:39]
    v_mfma_f32_16x16x32_bf16 v[40:43], a[200:203], v[128:131], v[40:43]
    v_mfma_f32_16x16x32_bf16 v[44:47], a[204:207], v[128:131], v[44:47]
    s_waitcnt vmcnt(8)
    v_mfma_f32_16x16x32_bf16 v[48:51], a[192:195], v[136:139], v[48:51]
    s_add_u32 s15, s33, s99
    buffer_load_dwordx4 v[140:143], v1, s[40:43], s15 offen sc1
    v_mfma_f32_16x16x32_bf16 v[52:55], a[196:199], v[136:139], v[52:55]
    v_mfma_f32_16x16x32_bf16 v[56:59], a[200:203], v[136:139], v[56:59]
    v_mfma_f32_16x16x32_bf16 v[60:63], a[204:207], v[136:139], v[60:63]
    s_waitcnt vmcnt(8)
    v_mfma_f32_16x16x32_bf16 v[64:67], a[192:195], v[144:147], v[64:67]
    s_add_u32 s15, s34, s99
    buffer_load_dwordx4 v[148:151], v1, s[40:43], s15 offen sc1
    v_mfma_f32_16x16x32_bf16 v[68:71], a[196:199], v[144:147], v[68:71]
    v_mfma_f32_16x16x32_bf16 v[72:75], a[200:203], v[144:147], v[72:75]
    v_mfma_f32_16x16x32_bf16 v[76:79], a[204:207], v[144:147], v[76:79]
    buffer_load_dword v101, v0, s[40:43], s12 offen sc1
    s_waitcnt vmcnt(9)
    v_mfma_f32_16x16x32_bf16 v[80:83], a[192:195], v[152:155], v[80:83]
    s_add_u32 s15, s35, s99
    buffer_load_dwordx4 v[156:159], v1, s[40:43], s15 offen sc1
    v_mfma_f32_16x16x32_bf16 v[84:87], a[196:199], v[152:155], v[84:87]
    v_mfma_f32_16x16x32_bf16 v[88:91], a[200:203], v[152:155], v[88:91]
    v_mfma_f32_16x16x32_bf16 v[92:95], a[204:207], v[152:155], v[92:95]
    s_waitcnt lgkmcnt(0)
    s_waitcnt vmcnt(8)
    v_mfma_f32_16x16x32_bf16 v[32:35], v[176:179], v[132:135], v[32:35]
    s_add_u32 s15, s32, s97
    buffer_load_dwordx4 v[128:131], v1, s[40:43], s15 offen sc1
    v_mfma_f32_16x16x32_bf16 v[36:39], v[180:183], v[132:135], v[36:39]
    ds_read_b128 v[240:243], v30 offset:12288
    v_mfma_f32_16x16x32_bf16 v[40:43], v[184:187], v[132:135], v[40:43]
    ds_read_b128 v[244:247], v30 offset:13312
    v_mfma_f32_16x16x32_bf16 v[44:47], v[188:191], v[132:135], v[44:47]
    ds_read_b128 v[248:251], v30 offset:14336
    s_waitcnt vmcnt(8)
    v_mfma_f32_16x16x32_bf16 v[48:51], v[176:179], v[160:163], v[48:51]
    s_add_u32 s15, s33, s97
    buffer_load_dwordx4 v[136:139], v1, s[40:43], s15 offen sc1
    v_mfma_f32_16x16x32_bf16 v[52:55], v[180:183], v[160:163], v[52:55]
    ds_read_b128 v[252:255], v30 offset:15360
    v_mfma_f32_16x16x32_bf16 v[56:59], v[184:187], v[160:163], v[56:59]
    v_mfma_f32_16x16x32_bf16 v[60:63], v[188:191], v[160:163], v[60:63]
    s_waitcnt vmcnt(8)
    v_mfma_f32_16x16x32_bf16 v[64:67], v[176:179], v[164:167], v[64:67]
    s_add_u32 s15, s34, s97
    buffer_load_dwordx4 v[144:147], v1, s[40:43], s15 offen sc1
    v_mfma_f32_16x16x32_bf16 v[68:71], v[180:183], v[164:167], v[68:71]
    v_mfma_f32_16x16x32_bf16 v[72:75], v[184:187], v[164:167], v[72:75]
    v_mfma_f32_16x16x32_bf16 v[76:79], v[188:191], v[164:167], v[76:79]
    s_waitcnt vmcnt(8)
    v_mfma_f32_16x16x32_bf16 v[80:83], v[176:179], v[168:171], v[80:83]
    s_add_u32 s15, s35, s97
    buffer_load_dwordx4 v[152:155], v1, s[40:43], s15 offen sc1
    v_mfma_f32_16x16x32_bf16 v[84:87], v[180:183], v[168:171], v[84:87]
    v_mfma_f32_16x16x32_bf16 v[88:91], v[184:187], v[168:171], v[88:91]
    v_mfma_f32_16x16x32_bf16 v[92:95], v[188:191], v[168:171], v[92:95]
    s_waitcnt vmcnt(8)
    v_mfma_f32_16x16x32_bf16 v[32:35], a[208:211], v[172:175], v[32:35]
    s_add_u32 s15, s32, s100
    buffer_load_dwordx4 v[132:135], v1, s[40:43], s15 offen sc1
    v_mfma_f32_16x16x32_bf16 v[36:39], a[212:215], v[172:175], v[36:39]
    v_mfma_f32_16x16x32_bf16 v[40:43], a[216:219], v[172:175], v[40:43]
    v_mfma_f32_16x16x32_bf16 v[44:47], a[220:223], v[172:175], v[44:47]
    s_waitcnt vmcnt(8)
    v_mfma_f32_16x16x32_bf16 v[48:51], a[208:211], v[140:143], v[48:51]
    s_add_u32 s15, s33, s100
    buffer_load_dwordx4 v[160:163], v1, s[40:43], s15 offen sc1
    v_mfma_f32_16x16x32_bf16 v[52:55], a[212:215], v[140:143], v[52:55]
    v_mfma_f32_16x16x32_bf16 v[56:59], a[216:219], v[140:143], v[56:59]
    v_mfma_f32_16x16x32_bf16 v[60:63], a[220:223], v[140:143], v[60:63]
    s_waitcnt vmcnt(8)
    v_mfma_f32_16x16x32_bf16 v[64:67], a[208:211], v[148:151], v[64:67]
    s_add_u32 s15, s34, s100
    buffer_load_dwordx4 v[164:167], v1, s[40:43], s15 offen sc1
    v_mfma_f32_16x16x32_bf16 v[68:71], a[212:215], v[148:151], v[68:71]
    v_mfma_f32_16x16x32_bf16 v[72:75], a[216:219], v[148:151], v[72:75]
    v_mfma_f32_16x16x32_bf16 v[76:79], a[220:223], v[148:151], v[76:79]
    s_waitcnt vmcnt(7)
    v_mfma_f32_16x16x32_bf16 v[80:83], a[208:211], v[156:159], v[80:83]
    s_add_u32 s15, s35, s100
    buffer_load_dwordx4 v[168:171], v1, s[40:43], s15 offen sc1
    v_mfma_f32_16x16x32_bf16 v[84:87], a[212:215], v[156:159], v[84:87]
    v_mfma_f32_16x16x32_bf16 v[88:91], a[216:219], v[156:159], v[88:91]
    v_mfma_f32_16x16x32_bf16 v[92:95], a[220:223], v[156:159], v[92:95]
    s_waitcnt lgkmcnt(0)
    s_waitcnt vmcnt(7)
    v_mfma_f32_16x16x32_bf16 v[32:35], v[240:243], v[128:131], v[32:35]
    s_add_u32 s15, s33, s101
    buffer_load_dwordx4 v[172:175], v1, s[40:43], s15 offen sc1
    v_mfma_f32_16x16x32_bf16 v[36:39], v[244:247], v[128:131], v[36:39]
    v_mfma_f32_16x16x32_bf16 v[40:43], v[248:251], v[128:131], v[40:43]
    v_mfma_f32_16x16x32_bf16 v[44:47], v[252:255], v[128:131], v[44:47]
    v_cmp_gt_u32 vcc, s30, v101
    s_cbranch_vccz apd_interleave_layers__ssm_conv_h3__dense_activation_relu__prompt_kernel_35
    s_mov_b32 s6, 100000
poll_interleave_layers__ssm_conv_h3__dense_activation_relu__prompt_kernel_36:
    buffer_load_dword v101, v0, s[40:43], s12 offen sc1
    s_waitcnt vmcnt(0)
    v_cmp_gt_u32 vcc, s30, v101
    s_cbranch_vccz done_interleave_layers__ssm_conv_h3__dense_activation_relu__prompt_kernel_37
    s_sub_u32 s6, s6, 1
    s_cmp_lg_u32 s6, 0
    s_cbranch_scc1 poll_interleave_layers__ssm_conv_h3__dense_activation_relu__prompt_kernel_36
done_interleave_layers__ssm_conv_h3__dense_activation_relu__prompt_kernel_37:
apd_interleave_layers__ssm_conv_h3__dense_activation_relu__prompt_kernel_35:
    s_cmp_lg_u32 s26, 0
    s_cbranch_scc1 acq_interleave_layers__ssm_conv_h3__dense_activation_relu__prompt_kernel_38
    buffer_inv sc1
    s_waitcnt vmcnt(0)
acq_interleave_layers__ssm_conv_h3__dense_activation_relu__prompt_kernel_38:
    s_waitcnt vmcnt(7)
    v_mfma_f32_16x16x32_bf16 v[48:51], v[240:243], v[136:139], v[48:51]
    s_add_u32 s15, s33, s20
    buffer_load_dwordx4 v[140:143], v1, s[40:43], s15 offen sc1
    v_mfma_f32_16x16x32_bf16 v[52:55], v[244:247], v[136:139], v[52:55]
    v_mfma_f32_16x16x32_bf16 v[56:59], v[248:251], v[136:139], v[56:59]
    v_mfma_f32_16x16x32_bf16 v[60:63], v[252:255], v[136:139], v[60:63]
    s_waitcnt vmcnt(7)
    v_mfma_f32_16x16x32_bf16 v[64:67], v[240:243], v[144:147], v[64:67]
    s_add_u32 s15, s33, s21
    buffer_load_dwordx4 v[148:151], v1, s[40:43], s15 offen sc1
    v_mfma_f32_16x16x32_bf16 v[68:71], v[244:247], v[144:147], v[68:71]
    v_mfma_f32_16x16x32_bf16 v[72:75], v[248:251], v[144:147], v[72:75]
    v_mfma_f32_16x16x32_bf16 v[76:79], v[252:255], v[144:147], v[76:79]
    s_waitcnt vmcnt(7)
    v_mfma_f32_16x16x32_bf16 v[80:83], v[240:243], v[152:155], v[80:83]
    s_add_u32 s15, s33, s22
    buffer_load_dwordx4 v[156:159], v26, s[40:43], s15 offen sc1
    v_mfma_f32_16x16x32_bf16 v[84:87], v[244:247], v[152:155], v[84:87]
    v_mfma_f32_16x16x32_bf16 v[88:91], v[248:251], v[152:155], v[88:91]
    v_mfma_f32_16x16x32_bf16 v[92:95], v[252:255], v[152:155], v[92:95]
    s_waitcnt vmcnt(7)
    v_mfma_f32_16x16x32_bf16 v[32:35], a[224:227], v[132:135], v[32:35]
    s_add_u32 s15, s34, s101
    buffer_load_dwordx4 v[128:131], v1, s[40:43], s15 offen sc1
    v_mfma_f32_16x16x32_bf16 v[36:39], a[228:231], v[132:135], v[36:39]
    v_lshlrev_b32 v240, 16, v108
    v_mfma_f32_16x16x32_bf16 v[40:43], a[232:235], v[132:135], v[40:43]
    v_mfma_f32_16x16x32_bf16 v[44:47], a[236:239], v[132:135], v[44:47]
    v_and_b32 v241, s28, v108
    s_waitcnt vmcnt(7)
    v_mfma_f32_16x16x32_bf16 v[48:51], a[224:227], v[160:163], v[48:51]
    s_add_u32 s15, s34, s20
    buffer_load_dwordx4 v[136:139], v1, s[40:43], s15 offen sc1
    v_mfma_f32_16x16x32_bf16 v[52:55], a[228:231], v[160:163], v[52:55]
    v_lshlrev_b32 v242, 16, v109
    v_mfma_f32_16x16x32_bf16 v[56:59], a[232:235], v[160:163], v[56:59]
    v_mfma_f32_16x16x32_bf16 v[60:63], a[236:239], v[160:163], v[60:63]
    v_and_b32 v243, s28, v109
    s_waitcnt vmcnt(7)
    v_mfma_f32_16x16x32_bf16 v[64:67], a[224:227], v[164:167], v[64:67]
    s_add_u32 s15, s34, s21
    buffer_load_dwordx4 v[144:147], v1, s[40:43], s15 offen sc1
    v_mfma_f32_16x16x32_bf16 v[68:71], a[228:231], v[164:167], v[68:71]
    v_lshlrev_b32 v244, 16, v110
    v_mfma_f32_16x16x32_bf16 v[72:75], a[232:235], v[164:167], v[72:75]
    v_mfma_f32_16x16x32_bf16 v[76:79], a[236:239], v[164:167], v[76:79]
    v_and_b32 v245, s28, v110
    s_waitcnt vmcnt(7)
    v_mfma_f32_16x16x32_bf16 v[80:83], a[224:227], v[168:171], v[80:83]
    s_add_u32 s15, s34, s22
    buffer_load_dwordx4 v[152:155], v26, s[40:43], s15 offen sc1
    v_mfma_f32_16x16x32_bf16 v[84:87], a[228:231], v[168:171], v[84:87]
    v_lshlrev_b32 v246, 16, v111
    v_mfma_f32_16x16x32_bf16 v[88:91], a[232:235], v[168:171], v[88:91]
    v_mfma_f32_16x16x32_bf16 v[92:95], a[236:239], v[168:171], v[92:95]
    v_and_b32 v247, s28, v111
    s_waitcnt vmcnt(7)
    v_mfma_f32_16x16x32_bf16 v[48:51], a[240:243], v[172:175], v[48:51]
    s_add_u32 s15, s35, s101
    buffer_load_dwordx4 v[132:135], v1, s[40:43], s15 offen sc1
    v_mfma_f32_16x16x32_bf16 v[52:55], a[244:247], v[172:175], v[52:55]
    v_lshlrev_b32 v248, 16, v124
    v_mfma_f32_16x16x32_bf16 v[56:59], a[248:251], v[172:175], v[56:59]
    v_mfma_f32_16x16x32_bf16 v[60:63], a[252:255], v[172:175], v[60:63]
    v_and_b32 v249, s28, v124
    s_waitcnt vmcnt(7)
    v_mfma_f32_16x16x32_bf16 v[48:51], v[192:195], v[140:143], v[48:51]
    s_add_u32 s15, s35, s20
    buffer_load_dwordx4 v[160:163], v1, s[40:43], s15 offen sc1
    v_mfma_f32_16x16x32_bf16 v[52:55], v[196:199], v[140:143], v[52:55]
    v_lshlrev_b32 v250, 16, v125
    v_mfma_f32_16x16x32_bf16 v[56:59], v[200:203], v[140:143], v[56:59]
    v_mfma_f32_16x16x32_bf16 v[60:63], v[204:207], v[140:143], v[60:63]
    v_and_b32 v251, s28, v125
    s_waitcnt vmcnt(7)
    v_mfma_f32_16x16x32_bf16 v[48:51], v[208:211], v[148:151], v[48:51]
    s_add_u32 s15, s35, s21
    buffer_load_dwordx4 v[164:167], v1, s[40:43], s15 offen sc1
    ds_read_b64_tr_b16 v[100:101], v10 offset:0
    v_mfma_f32_16x16x32_bf16 v[52:55], v[212:215], v[148:151], v[52:55]
    v_lshlrev_b32 v252, 16, v126
    ds_read_b64_tr_b16 v[102:103], v10 offset:512
    v_mfma_f32_16x16x32_bf16 v[56:59], v[216:219], v[148:151], v[56:59]
    ds_read_b64_tr_b16 v[104:105], v10 offset:4096
    v_mfma_f32_16x16x32_bf16 v[60:63], v[220:223], v[148:151], v[60:63]
    v_and_b32 v253, s28, v126
    ds_read_b64_tr_b16 v[106:107], v10 offset:4608
    s_waitcnt vmcnt(7)
    v_mfma_f32_16x16x32_bf16 v[48:51], v[224:227], v[156:159], v[48:51]
    s_add_u32 s15, s35, s22
    buffer_load_dwordx4 v[168:171], v26, s[40:43], s15 offen sc1
    v_mfma_f32_16x16x32_bf16 v[52:55], v[228:231], v[156:159], v[52:55]
    v_lshlrev_b32 v254, 16, v127
    v_mfma_f32_16x16x32_bf16 v[56:59], v[232:235], v[156:159], v[56:59]
    v_mfma_f32_16x16x32_bf16 v[60:63], v[236:239], v[156:159], v[60:63]
    v_and_b32 v255, s28, v127
    s_waitcnt vmcnt(7)
    v_mfma_f32_16x16x32_bf16 v[64:67], a[240:243], v[128:131], v[64:67]
    s_add_u32 s15, s32, s101
    buffer_load_dwordx4 v[172:175], v1, s[40:43], s15 offen sc1
    s_waitcnt lgkmcnt(0)
    v_lshlrev_b32 v176, 16, v100
    v_mfma_f32_16x16x32_bf16 v[68:71], a[244:247], v[128:131], v[68:71]
    v_mfma_f32_16x16x32_bf16 v[72:75], a[248:251], v[128:131], v[72:75]
    v_and_b32 v177, s28, v100
    v_mfma_f32_16x16x32_bf16 v[76:79], a[252:255], v[128:131], v[76:79]
    ds_write_b128 v97, v[48:51] offset:0
    s_waitcnt vmcnt(7)
    v_mfma_f32_16x16x32_bf16 v[64:67], v[192:195], v[136:139], v[64:67]
    s_add_u32 s15, s32, s20
    buffer_load_dwordx4 v[140:143], v1, s[40:43], s15 offen sc1
    v_lshlrev_b32 v178, 16, v101
    v_mfma_f32_16x16x32_bf16 v[68:71], v[196:199], v[136:139], v[68:71]
    ds_write_b128 v97, v[52:55] offset:1024
    v_mfma_f32_16x16x32_bf16 v[72:75], v[200:203], v[136:139], v[72:75]
    v_and_b32 v179, s28, v101
    v_mfma_f32_16x16x32_bf16 v[76:79], v[204:207], v[136:139], v[76:79]
    ds_write_b128 v97, v[56:59] offset:2048
    s_waitcnt vmcnt(7)
    v_mfma_f32_16x16x32_bf16 v[64:67], v[208:211], v[144:147], v[64:67]
    s_add_u32 s15, s32, s21
    buffer_load_dwordx4 v[148:151], v1, s[40:43], s15 offen sc1
    v_lshlrev_b32 v180, 16, v102
    v_mfma_f32_16x16x32_bf16 v[68:71], v[212:215], v[144:147], v[68:71]
    ds_write_b128 v97, v[60:63] offset:3072
    v_mfma_f32_16x16x32_bf16 v[72:75], v[216:219], v[144:147], v[72:75]
    v_and_b32 v181, s28, v102
    v_mfma_f32_16x16x32_bf16 v[76:79], v[220:223], v[144:147], v[76:79]
    s_waitcnt vmcnt(7)
    v_mfma_f32_16x16x32_bf16 v[64:67], v[224:227], v[152:155], v[64:67]
    s_add_u32 s15, s32, s22
    buffer_load_dwordx4 v[156:159], v26, s[40:43], s15 offen sc1
    v_lshlrev_b32 v182, 16, v103
    v_mfma_f32_16x16x32_bf16 v[68:71], v[228:231], v[152:155], v[68:71]
    v_mfma_f32_16x16x32_bf16 v[72:75], v[232:235], v[152:155], v[72:75]
    v_and_b32 v183, s28, v103
    v_mfma_f32_16x16x32_bf16 v[76:79], v[236:239], v[152:155], v[76:79]
    s_waitcnt vmcnt(7)
    v_mfma_f32_16x16x32_bf16 v[80:83], a[240:243], v[132:135], v[80:83]
    v_lshlrev_b32 v184, 16, v104
    v_mfma_f32_16x16x32_bf16 v[84:87], a[244:247], v[132:135], v[84:87]
    v_mfma_f32_16x16x32_bf16 v[88:91], a[248:251], v[132:135], v[88:91]
    v_and_b32 v185, s28, v104
    v_mfma_f32_16x16x32_bf16 v[92:95], a[252:255], v[132:135], v[92:95]
    ds_write_b128 v98, v[64:67] offset:4096
    s_waitcnt vmcnt(6)
    v_mfma_f32_16x16x32_bf16 v[80:83], v[192:195], v[160:163], v[80:83]
    v_lshlrev_b32 v186, 16, v105
    v_mfma_f32_16x16x32_bf16 v[84:87], v[196:199], v[160:163], v[84:87]
    ds_write_b128 v98, v[68:71] offset:5120
    v_mfma_f32_16x16x32_bf16 v[88:91], v[200:203], v[160:163], v[88:91]
    v_and_b32 v187, s28, v105
    v_mfma_f32_16x16x32_bf16 v[92:95], v[204:207], v[160:163], v[92:95]
    ds_write_b128 v98, v[72:75] offset:6144
    s_waitcnt vmcnt(5)
    v_mfma_f32_16x16x32_bf16 v[80:83], v[208:211], v[164:167], v[80:83]
    v_lshlrev_b32 v188, 16, v106
    v_mfma_f32_16x16x32_bf16 v[84:87], v[212:215], v[164:167], v[84:87]
    ds_write_b128 v98, v[76:79] offset:7168
    v_mfma_f32_16x16x32_bf16 v[88:91], v[216:219], v[164:167], v[88:91]
    v_and_b32 v189, s28, v106
    v_mfma_f32_16x16x32_bf16 v[92:95], v[220:223], v[164:167], v[92:95]
    s_waitcnt vmcnt(4)
    v_mfma_f32_16x16x32_bf16 v[80:83], v[224:227], v[168:171], v[80:83]
    v_lshlrev_b32 v190, 16, v107
    v_mfma_f32_16x16x32_bf16 v[84:87], v[228:231], v[168:171], v[84:87]
    v_mfma_f32_16x16x32_bf16 v[88:91], v[232:235], v[168:171], v[88:91]
    v_and_b32 v191, s28, v107
    v_mfma_f32_16x16x32_bf16 v[92:95], v[236:239], v[168:171], v[92:95]
    s_waitcnt vmcnt(3)
    v_mfma_f32_16x16x32_bf16 v[32:35], a[240:243], v[172:175], v[32:35]
    s_waitcnt lgkmcnt(0)
    s_barrier
    ds_read_b128 v[48:51], v96 offset:0
    ds_read_b128 v[52:55], v96 offset:1024
    ds_read_b128 v[56:59], v96 offset:2048
    ds_read_b128 v[60:63], v96 offset:3072
    ds_read_b128 v[64:67], v96 offset:4096
    ds_read_b128 v[68:71], v96 offset:5120
    ds_read_b128 v[72:75], v96 offset:6144
    ds_read_b128 v[76:79], v96 offset:7168
    v_mfma_f32_16x16x32_bf16 v[36:39], a[244:247], v[172:175], v[36:39]
    v_mfma_f32_16x16x32_bf16 v[40:43], a[248:251], v[172:175], v[40:43]
    v_mfma_f32_16x16x32_bf16 v[44:47], a[252:255], v[172:175], v[44:47]
    ds_write_b128 v99, v[80:83] offset:8192
    s_waitcnt vmcnt(2)
    v_mfma_f32_16x16x32_bf16 v[32:35], v[192:195], v[140:143], v[32:35]
    v_mfma_f32_16x16x32_bf16 v[36:39], v[196:199], v[140:143], v[36:39]
    ds_write_b128 v99, v[84:87] offset:9216
    v_mfma_f32_16x16x32_bf16 v[40:43], v[200:203], v[140:143], v[40:43]
    v_mfma_f32_16x16x32_bf16 v[44:47], v[204:207], v[140:143], v[44:47]
    ds_write_b128 v99, v[88:91] offset:10240
    s_waitcnt vmcnt(1)
    v_mfma_f32_16x16x32_bf16 v[32:35], v[208:211], v[148:151], v[32:35]
    s_waitcnt lgkmcnt(3)
    v_add_f32 v48, v48, v64
    v_add_f32 v49, v49, v65
    v_mfma_f32_16x16x32_bf16 v[36:39], v[212:215], v[148:151], v[36:39]
    ds_write_b128 v99, v[92:95] offset:11264
    v_add_f32 v50, v50, v66
    v_add_f32 v51, v51, v67
    v_mfma_f32_16x16x32_bf16 v[40:43], v[216:219], v[148:151], v[40:43]
    v_add_f32 v52, v52, v68
    v_add_f32 v53, v53, v69
    v_mfma_f32_16x16x32_bf16 v[44:47], v[220:223], v[148:151], v[44:47]
    v_add_f32 v54, v54, v70
    v_add_f32 v55, v55, v71
    s_waitcnt vmcnt(0)
    v_mfma_f32_16x16x32_bf16 v[32:35], v[224:227], v[156:159], v[32:35]
    v_add_f32 v56, v56, v72
    v_add_f32 v57, v57, v73
    v_mfma_f32_16x16x32_bf16 v[36:39], v[228:231], v[156:159], v[36:39]
    v_add_f32 v58, v58, v74
    v_add_f32 v59, v59, v75
    v_mfma_f32_16x16x32_bf16 v[40:43], v[232:235], v[156:159], v[40:43]
    v_add_f32 v60, v60, v76
    v_add_f32 v61, v61, v77
    v_mfma_f32_16x16x32_bf16 v[44:47], v[236:239], v[156:159], v[44:47]
    v_add_f32 v62, v62, v78
    v_add_f32 v63, v63, v79
    s_waitcnt lgkmcnt(0)
    s_barrier
    ds_read_b128 v[80:83], v96 offset:8192
    ds_read_b128 v[84:87], v96 offset:9216
    ds_read_b128 v[88:91], v96 offset:10240
    ds_read_b128 v[92:95], v96 offset:11264
    v_pk_add_f32 v[32:33], v[32:33], v[48:49]
    v_pk_add_f32 v[34:35], v[34:35], v[50:51]
    v_pk_add_f32 v[36:37], v[36:37], v[52:53]
    v_pk_add_f32 v[38:39], v[38:39], v[54:55]
    v_pk_add_f32 v[40:41], v[40:41], v[56:57]
    v_pk_add_f32 v[42:43], v[42:43], v[58:59]
    v_pk_add_f32 v[44:45], v[44:45], v[60:61]
    v_pk_add_f32 v[46:47], v[46:47], v[62:63]
    s_waitcnt lgkmcnt(2)
    v_pk_add_f32 v[32:33], v[32:33], v[80:81]
    v_pk_add_f32 v[34:35], v[34:35], v[82:83]
    v_pk_add_f32 v[36:37], v[36:37], v[84:85]
    v_pk_add_f32 v[38:39], v[38:39], v[86:87]
    s_waitcnt lgkmcnt(0)
    v_pk_add_f32 v[40:41], v[40:41], v[88:89]
    v_pk_add_f32 v[42:43], v[42:43], v[90:91]
    v_pk_add_f32 v[44:45], v[44:45], v[92:93]
    v_pk_add_f32 v[46:47], v[46:47], v[94:95]
    v_pk_fma_f32 v[240:241], v[32:33], v[14:15], v[240:241] op_sel_hi:[1,0,1]
    v_cvt_pk_bf16_f32 v160, v240, v241
    v_pk_fma_f32 v[242:243], v[34:35], v[14:15], v[242:243] op_sel_hi:[1,0,1]
    v_cvt_pk_bf16_f32 v161, v242, v243
    v_pk_fma_f32 v[244:245], v[36:37], v[14:15], v[244:245] op_sel_hi:[1,0,1]
    v_cvt_pk_bf16_f32 v162, v244, v245
    v_pk_fma_f32 v[246:247], v[38:39], v[14:15], v[246:247] op_sel_hi:[1,0,1]
    v_cvt_pk_bf16_f32 v163, v246, v247
    v_pk_fma_f32 v[248:249], v[40:41], v[14:15], v[248:249] op_sel_hi:[1,0,1]
    v_cvt_pk_bf16_f32 v164, v248, v249
    v_pk_fma_f32 v[250:251], v[42:43], v[14:15], v[250:251] op_sel_hi:[1,0,1]
    v_cvt_pk_bf16_f32 v165, v250, v251
    v_pk_fma_f32 v[252:253], v[44:45], v[14:15], v[252:253] op_sel_hi:[1,0,1]
    v_cvt_pk_bf16_f32 v166, v252, v253
    v_pk_fma_f32 v[254:255], v[46:47], v[14:15], v[254:255] op_sel_hi:[1,0,1]
    v_cvt_pk_bf16_f32 v167, v254, v255
    s_add_u32 s27, s27, 1
    s_bitcmp1_b32 s27, 0
    s_cbranch_scc1 L_loop
    buffer_store_dwordx4 v[160:163], v25, s[44:47], 0 offen
    buffer_store_dwordx4 v[164:167], v25, s[44:47], 0 offen offset:64
L_end:
    s_endpgm
.section .rodata,"a"
.p2align 6
.amdhsa_kernel interleave_layers__ssm_conv_h3__dense_activation_relu__prompt_kernel
  .amdhsa_next_free_vgpr 512
  .amdhsa_next_free_sgpr 102
  .amdhsa_accum_offset 256
  .amdhsa_group_segment_fixed_size 0
  .amdhsa_kernarg_size 96
  .amdhsa_user_sgpr_count 2
  .amdhsa_user_sgpr_kernarg_segment_ptr 1
  .amdhsa_system_sgpr_workgroup_id_x 1
.end_amdhsa_kernel
```
